```python
import torch

def _softmax(x, axis=-1):
    return torch.softmax(x, dim=axis)
def _gelu(x):
    return torch.nn.functional.gelu(x, approximate="tanh")
def _silu(x):
    return torch.nn.functional.silu(x)
def _sigmoid(x):
    return torch.sigmoid(x)
def _layernorm(x, axis=-1, eps=1e-5):
    m = x.mean(dim=axis, keepdim=True)
    v = x.var(dim=axis, keepdim=True, unbiased=False)
    return (x - m) / torch.sqrt(v + eps)
def _scatter_add(tgt, idx, src, axis=0):
    return tgt.clone().index_add_(axis, idx, src)
def _segment_sum(src, seg, n):
    out = torch.zeros((n,) + src.shape[1:], dtype=src.dtype)
    return out.index_add_(0, seg, src)
def _pad(x, pw):
    flat = tuple(v for pair in reversed(pw) for v in pair)
    return torch.nn.functional.pad(x, flat)

kernel_name = 'standalone__gqa_softmax__sampling'

def setup_inputs():

    _w = (lambda a: (lambda t: t.to(torch.bfloat16) if t.is_floating_point() else t)(torch.as_tensor(a)))
    B, Hq, Hkv, Sq, Sk, D = 8, 32, 4, 4, 8192, 128
    return {
        "q": _w((lambda *s: torch.randn(*s, dtype=torch.bfloat16) * 0.8)(B, Hq, Sq, D)),
        "k": _w((lambda *s: torch.randn(*s, dtype=torch.bfloat16) * 0.8)(B, Hkv, Sk, D)),
        "v": _w((lambda *s: torch.randn(*s, dtype=torch.bfloat16) * 0.05)(B, Hkv, Sk, D)),
    }

def reference(q, k, v):
    B, Hq, Sq, D = q.shape
    Hkv = k.shape[1]
    rep = Hq // Hkv
    k = (lambda x, n, axis: torch.repeat_interleave(x, n, dim=axis))(k, rep, axis=1)
    v = (lambda x, n, axis: torch.repeat_interleave(x, n, dim=axis))(v, rep, axis=1)
    scale = D ** -0.5
    scores = torch.einsum("bhqd,bhkd->bhqk", q, k) * scale
    p = _softmax(scores, axis=-1)
    return torch.einsum("bhqk,bhkd->bhqd", p, v)
```

```asm
; @launch grid=(256,1,1) block=(320,1,1) lds=151552
.amdgcn_target "amdgcn-amd-amdhsa--gfx950"
.text
.globl standalone__gqa_softmax__sampling_kernel
.p2align 8
.type standalone__gqa_softmax__sampling_kernel,@function
standalone__gqa_softmax__sampling_kernel:
    s_load_dwordx8 s[4:11], s[0:1], 0
    s_load_dwordx2 s[28:29], s[0:1], 40
    s_cmp_ge_u32 s2, 0x100
    s_cbranch_scc1 L_end
    v_lshrrev_b32 v1, 6, v0
    v_and_b32 v0, 63, v0
    v_readfirstlane_b32 s36, v1
    s_bfe_u32 s40, s2, 0x20000
    s_lshl_b32 s40, s40, 4
    s_bfe_u32 s41, s2, 0x10002
    s_lshl_b32 s41, s41, 7
    s_or_b32 s40, s40, s41
    s_bfe_u32 s41, s2, 0x40003
    s_or_b32 s40, s40, s41
    s_bfe_u32 s41, s2, 0x10007
    s_lshl_b32 s41, s41, 6
    s_or_b32 s40, s40, s41
    s_lshr_b32 s38, s40, 3
    s_and_b32 s39, s40, 7
    s_lshl_b32 s40, s40, 18
    v_lshrrev_b32 v6, 4, v0
    v_and_b32 v7, 15, v0
    v_xor_b32 v8, v7, v6
    v_lshlrev_b32 v8, 4, v8
    v_lshl_add_u32 v1, v6, 8, v8
    v_xor_b32 v2, 64, v1
    v_xor_b32 v3, 0x80, v1
    v_xor_b32 v4, 0xc0, v1
    s_mov_b32 s18, 0x40000
    s_mov_b32 s19, 0x20000
    s_lshl_b32 s37, s36, 15
    s_add_u32 s37, s37, 20480
    s_lshl_b32 s44, s36, 13
    s_mov_b32 m0, s37
    s_add_u32 s43, s44, 0x1000
    s_cmp_eq_u32 s36, 4
    s_waitcnt lgkmcnt(0)
    s_cbranch_scc1 L_loader
    s_add_u32 s16, s6, s40
    s_addc_u32 s17, s7, 0
    buffer_load_dwordx4 v1, s[16:19], s44 offen offset:0 nt lds
    buffer_load_dwordx4 v2, s[16:19], s44 offen offset:1024 nt lds
    buffer_load_dwordx4 v3, s[16:19], s44 offen offset:2048 nt lds
    buffer_load_dwordx4 v4, s[16:19], s44 offen offset:3072 nt lds
    s_add_u32 m0, s37, 4096
    s_lshl_b32 s41, s38, 13
    buffer_load_dwordx4 v1, s[16:19], s43 offen offset:0 nt lds
    buffer_load_dwordx4 v2, s[16:19], s43 offen offset:1024 nt lds
    buffer_load_dwordx4 v3, s[16:19], s43 offen offset:2048 nt lds
    buffer_load_dwordx4 v4, s[16:19], s43 offen offset:3072 nt lds
    s_add_u32 s24, s4, s41
    s_addc_u32 s25, s5, 0
    s_mov_b32 s26, 0x2000
    s_mov_b32 s27, 0x20000
    s_and_b32 s41, s36, 1
    s_lshl_b32 s41, s41, 7
    v_xor_b32 v9, s41, v1
    v_xor_b32 v10, s41, v2
    s_lshl_b32 s41, s36, 11
    s_mov_b32 m0, s41
    s_mov_b32 s30, 0x280000
    s_mov_b32 s31, 0x20000
    buffer_load_dwordx4 v9, s[24:27], s41 offen lds
    buffer_load_dwordx4 v10, s[24:27], s41 offen offset:1024 lds
    s_branch L_compute
L_loader:
    s_setprio 3
    s_add_u32 s16, s6, s40
    s_addc_u32 s17, s7, 0
    s_add_u32 s20, s8, s40
    s_addc_u32 s21, s9, 0
    s_mov_b32 s22, 0x40000
    s_mov_b32 s23, 0x20000
    v_lshlrev_b32 v8, 2, v6
    v_xor_b32 v8, v7, v8
    v_lshlrev_b32 v8, 4, v8
    v_lshl_add_u32 v5, v6, 8, v8
    s_mov_b32 m0, 28672
    s_mov_b32 s44, 32768
    buffer_load_dwordx4 v1, s[16:19], s44 offen offset:0 nt lds
    buffer_load_dwordx4 v2, s[16:19], s44 offen offset:1024 nt lds
    buffer_load_dwordx4 v3, s[16:19], s44 offen offset:2048 nt lds
    buffer_load_dwordx4 v4, s[16:19], s44 offen offset:3072 nt lds
    s_mov_b32 m0, 32768
    s_mov_b32 s44, 36864
    buffer_load_dwordx4 v1, s[16:19], s44 offen offset:0 nt lds
    buffer_load_dwordx4 v2, s[16:19], s44 offen offset:1024 nt lds
    buffer_load_dwordx4 v3, s[16:19], s44 offen offset:2048 nt lds
    buffer_load_dwordx4 v4, s[16:19], s44 offen offset:3072 nt lds
    s_mov_b32 m0, 61440
    s_mov_b32 s44, 40960
    buffer_load_dwordx4 v1, s[16:19], s44 offen offset:0 nt lds
    buffer_load_dwordx4 v2, s[16:19], s44 offen offset:1024 nt lds
    buffer_load_dwordx4 v3, s[16:19], s44 offen offset:2048 nt lds
    buffer_load_dwordx4 v4, s[16:19], s44 offen offset:3072 nt lds
    s_mov_b32 m0, 65536
    s_mov_b32 s44, 45056
    buffer_load_dwordx4 v1, s[16:19], s44 offen offset:0 nt lds
    buffer_load_dwordx4 v2, s[16:19], s44 offen offset:1024 nt lds
    buffer_load_dwordx4 v3, s[16:19], s44 offen offset:2048 nt lds
    buffer_load_dwordx4 v4, s[16:19], s44 offen offset:3072 nt lds
    s_mov_b32 m0, 94208
    s_mov_b32 s44, 49152
    buffer_load_dwordx4 v1, s[16:19], s44 offen offset:0 nt lds
    buffer_load_dwordx4 v2, s[16:19], s44 offen offset:1024 nt lds
    buffer_load_dwordx4 v3, s[16:19], s44 offen offset:2048 nt lds
    buffer_load_dwordx4 v4, s[16:19], s44 offen offset:3072 nt lds
    s_mov_b32 m0, 98304
    s_mov_b32 s44, 53248
    buffer_load_dwordx4 v1, s[16:19], s44 offen offset:0 nt lds
    buffer_load_dwordx4 v2, s[16:19], s44 offen offset:1024 nt lds
    buffer_load_dwordx4 v3, s[16:19], s44 offen offset:2048 nt lds
    buffer_load_dwordx4 v4, s[16:19], s44 offen offset:3072 nt lds
    s_mov_b32 m0, 126976
    s_mov_b32 s44, 57344
    buffer_load_dwordx4 v1, s[16:19], s44 offen offset:0 nt lds
    buffer_load_dwordx4 v2, s[16:19], s44 offen offset:1024 nt lds
    buffer_load_dwordx4 v3, s[16:19], s44 offen offset:2048 nt lds
    buffer_load_dwordx4 v4, s[16:19], s44 offen offset:3072 nt lds
    s_mov_b32 m0, 131072
    s_mov_b32 s44, 61440
    buffer_load_dwordx4 v1, s[16:19], s44 offen offset:0 nt lds
    buffer_load_dwordx4 v2, s[16:19], s44 offen offset:1024 nt lds
    buffer_load_dwordx4 v3, s[16:19], s44 offen offset:2048 nt lds
    buffer_load_dwordx4 v4, s[16:19], s44 offen offset:3072 nt lds
    s_mov_b32 m0, 36864
    s_mov_b32 s44, 65536
    buffer_load_dwordx4 v1, s[16:19], s44 offen offset:0 nt lds
    buffer_load_dwordx4 v2, s[16:19], s44 offen offset:1024 nt lds
    buffer_load_dwordx4 v3, s[16:19], s44 offen offset:2048 nt lds
    buffer_load_dwordx4 v4, s[16:19], s44 offen offset:3072 nt lds
    s_mov_b32 m0, 40960
    s_mov_b32 s44, 69632
    buffer_load_dwordx4 v1, s[16:19], s44 offen offset:0 nt lds
    buffer_load_dwordx4 v2, s[16:19], s44 offen offset:1024 nt lds
    buffer_load_dwordx4 v3, s[16:19], s44 offen offset:2048 nt lds
    buffer_load_dwordx4 v4, s[16:19], s44 offen offset:3072 nt lds
    s_waitcnt vmcnt(40)
    s_barrier
    s_mov_b32 m0, 69632
    s_mov_b32 s44, 73728
    buffer_load_dwordx4 v1, s[16:19], s44 offen offset:0 nt lds
    buffer_load_dwordx4 v2, s[16:19], s44 offen offset:1024 nt lds
    buffer_load_dwordx4 v3, s[16:19], s44 offen offset:2048 nt lds
    buffer_load_dwordx4 v4, s[16:19], s44 offen offset:3072 nt lds
    s_waitcnt vmcnt(40)
    s_mov_b32 m0, 73728
    s_mov_b32 s44, 77824
    buffer_load_dwordx4 v1, s[16:19], s44 offen offset:0 nt lds
    buffer_load_dwordx4 v2, s[16:19], s44 offen offset:1024 nt lds
    buffer_load_dwordx4 v3, s[16:19], s44 offen offset:2048 nt lds
    buffer_load_dwordx4 v4, s[16:19], s44 offen offset:3072 nt lds
    s_waitcnt vmcnt(40)
    s_mov_b32 m0, 102400
    s_mov_b32 s44, 81920
    buffer_load_dwordx4 v1, s[16:19], s44 offen offset:0 nt lds
    buffer_load_dwordx4 v2, s[16:19], s44 offen offset:1024 nt lds
    buffer_load_dwordx4 v3, s[16:19], s44 offen offset:2048 nt lds
    buffer_load_dwordx4 v4, s[16:19], s44 offen offset:3072 nt lds
    s_waitcnt vmcnt(40)
    s_mov_b32 m0, 106496
    s_mov_b32 s44, 86016
    buffer_load_dwordx4 v1, s[16:19], s44 offen offset:0 nt lds
    buffer_load_dwordx4 v2, s[16:19], s44 offen offset:1024 nt lds
    buffer_load_dwordx4 v3, s[16:19], s44 offen offset:2048 nt lds
    buffer_load_dwordx4 v4, s[16:19], s44 offen offset:3072 nt lds
    s_waitcnt vmcnt(40)
    s_mov_b32 m0, 135168
    s_mov_b32 s44, 90112
    buffer_load_dwordx4 v1, s[16:19], s44 offen offset:0 nt lds
    buffer_load_dwordx4 v2, s[16:19], s44 offen offset:1024 nt lds
    buffer_load_dwordx4 v3, s[16:19], s44 offen offset:2048 nt lds
    buffer_load_dwordx4 v4, s[16:19], s44 offen offset:3072 nt lds
    s_waitcnt vmcnt(40)
    s_mov_b32 m0, 139264
    s_mov_b32 s44, 94208
    buffer_load_dwordx4 v1, s[16:19], s44 offen offset:0 nt lds
    buffer_load_dwordx4 v2, s[16:19], s44 offen offset:1024 nt lds
    buffer_load_dwordx4 v3, s[16:19], s44 offen offset:2048 nt lds
    buffer_load_dwordx4 v4, s[16:19], s44 offen offset:3072 nt lds
    s_waitcnt vmcnt(40)
    s_mov_b32 m0, 45056
    s_mov_b32 s44, 98304
    buffer_load_dwordx4 v1, s[16:19], s44 offen offset:0 nt lds
    buffer_load_dwordx4 v2, s[16:19], s44 offen offset:1024 nt lds
    buffer_load_dwordx4 v3, s[16:19], s44 offen offset:2048 nt lds
    buffer_load_dwordx4 v4, s[16:19], s44 offen offset:3072 nt lds
    s_waitcnt vmcnt(40)
    s_mov_b32 m0, 49152
    s_mov_b32 s44, 102400
    buffer_load_dwordx4 v1, s[16:19], s44 offen offset:0 nt lds
    buffer_load_dwordx4 v2, s[16:19], s44 offen offset:1024 nt lds
    buffer_load_dwordx4 v3, s[16:19], s44 offen offset:2048 nt lds
    buffer_load_dwordx4 v4, s[16:19], s44 offen offset:3072 nt lds
    s_waitcnt vmcnt(40)
    s_barrier
    s_mov_b32 m0, 77824
    s_mov_b32 s44, 106496
    buffer_load_dwordx4 v1, s[16:19], s44 offen offset:0 nt lds
    buffer_load_dwordx4 v2, s[16:19], s44 offen offset:1024 nt lds
    buffer_load_dwordx4 v3, s[16:19], s44 offen offset:2048 nt lds
    buffer_load_dwordx4 v4, s[16:19], s44 offen offset:3072 nt lds
    s_waitcnt vmcnt(40)
    s_mov_b32 m0, 81920
    s_mov_b32 s44, 110592
    buffer_load_dwordx4 v1, s[16:19], s44 offen offset:0 nt lds
    buffer_load_dwordx4 v2, s[16:19], s44 offen offset:1024 nt lds
    buffer_load_dwordx4 v3, s[16:19], s44 offen offset:2048 nt lds
    buffer_load_dwordx4 v4, s[16:19], s44 offen offset:3072 nt lds
    s_waitcnt vmcnt(40)
    s_mov_b32 m0, 110592
    s_mov_b32 s44, 114688
    buffer_load_dwordx4 v1, s[16:19], s44 offen offset:0 nt lds
    buffer_load_dwordx4 v2, s[16:19], s44 offen offset:1024 nt lds
    buffer_load_dwordx4 v3, s[16:19], s44 offen offset:2048 nt lds
    buffer_load_dwordx4 v4, s[16:19], s44 offen offset:3072 nt lds
    s_waitcnt vmcnt(40)
    s_mov_b32 m0, 114688
    s_mov_b32 s44, 118784
    buffer_load_dwordx4 v1, s[16:19], s44 offen offset:0 nt lds
    buffer_load_dwordx4 v2, s[16:19], s44 offen offset:1024 nt lds
    buffer_load_dwordx4 v3, s[16:19], s44 offen offset:2048 nt lds
    buffer_load_dwordx4 v4, s[16:19], s44 offen offset:3072 nt lds
    s_waitcnt vmcnt(40)
    s_mov_b32 m0, 143360
    s_mov_b32 s44, 122880
    buffer_load_dwordx4 v1, s[16:19], s44 offen offset:0 nt lds
    buffer_load_dwordx4 v2, s[16:19], s44 offen offset:1024 nt lds
    buffer_load_dwordx4 v3, s[16:19], s44 offen offset:2048 nt lds
    buffer_load_dwordx4 v4, s[16:19], s44 offen offset:3072 nt lds
    s_waitcnt vmcnt(40)
    s_mov_b32 m0, 147456
    s_mov_b32 s44, 126976
    buffer_load_dwordx4 v1, s[16:19], s44 offen offset:0 nt lds
    buffer_load_dwordx4 v2, s[16:19], s44 offen offset:1024 nt lds
    buffer_load_dwordx4 v3, s[16:19], s44 offen offset:2048 nt lds
    buffer_load_dwordx4 v4, s[16:19], s44 offen offset:3072 nt lds
    s_waitcnt vmcnt(40)
    s_mov_b32 m0, 20480
    s_mov_b32 s44, 131072
    buffer_load_dwordx4 v1, s[16:19], s44 offen offset:0 nt lds
    buffer_load_dwordx4 v2, s[16:19], s44 offen offset:1024 nt lds
    buffer_load_dwordx4 v3, s[16:19], s44 offen offset:2048 nt lds
    buffer_load_dwordx4 v4, s[16:19], s44 offen offset:3072 nt lds
    s_waitcnt vmcnt(40)
    s_mov_b32 m0, 24576
    s_mov_b32 s44, 135168
    buffer_load_dwordx4 v1, s[16:19], s44 offen offset:0 nt lds
    buffer_load_dwordx4 v2, s[16:19], s44 offen offset:1024 nt lds
    buffer_load_dwordx4 v3, s[16:19], s44 offen offset:2048 nt lds
    buffer_load_dwordx4 v4, s[16:19], s44 offen offset:3072 nt lds
    s_waitcnt vmcnt(40)
    s_barrier
    s_mov_b32 m0, 53248
    s_mov_b32 s44, 139264
    buffer_load_dwordx4 v1, s[16:19], s44 offen offset:0 nt lds
    buffer_load_dwordx4 v2, s[16:19], s44 offen offset:1024 nt lds
    buffer_load_dwordx4 v3, s[16:19], s44 offen offset:2048 nt lds
    buffer_load_dwordx4 v4, s[16:19], s44 offen offset:3072 nt lds
    s_waitcnt vmcnt(40)
    s_mov_b32 m0, 57344
    s_mov_b32 s44, 143360
    buffer_load_dwordx4 v1, s[16:19], s44 offen offset:0 nt lds
    buffer_load_dwordx4 v2, s[16:19], s44 offen offset:1024 nt lds
    buffer_load_dwordx4 v3, s[16:19], s44 offen offset:2048 nt lds
    buffer_load_dwordx4 v4, s[16:19], s44 offen offset:3072 nt lds
    s_waitcnt vmcnt(40)
    s_mov_b32 m0, 86016
    s_mov_b32 s44, 147456
    buffer_load_dwordx4 v1, s[16:19], s44 offen offset:0 nt lds
    buffer_load_dwordx4 v2, s[16:19], s44 offen offset:1024 nt lds
    buffer_load_dwordx4 v3, s[16:19], s44 offen offset:2048 nt lds
    buffer_load_dwordx4 v4, s[16:19], s44 offen offset:3072 nt lds
    s_waitcnt vmcnt(40)
    s_mov_b32 m0, 90112
    s_mov_b32 s44, 151552
    buffer_load_dwordx4 v1, s[16:19], s44 offen offset:0 nt lds
    buffer_load_dwordx4 v2, s[16:19], s44 offen offset:1024 nt lds
    buffer_load_dwordx4 v3, s[16:19], s44 offen offset:2048 nt lds
    buffer_load_dwordx4 v4, s[16:19], s44 offen offset:3072 nt lds
    s_waitcnt vmcnt(40)
    s_mov_b32 m0, 118784
    s_mov_b32 s44, 155648
    buffer_load_dwordx4 v1, s[16:19], s44 offen offset:0 nt lds
    buffer_load_dwordx4 v2, s[16:19], s44 offen offset:1024 nt lds
    buffer_load_dwordx4 v3, s[16:19], s44 offen offset:2048 nt lds
    buffer_load_dwordx4 v4, s[16:19], s44 offen offset:3072 nt lds
    s_waitcnt vmcnt(40)
    s_mov_b32 m0, 122880
    s_mov_b32 s44, 159744
    buffer_load_dwordx4 v1, s[16:19], s44 offen offset:0 nt lds
    buffer_load_dwordx4 v2, s[16:19], s44 offen offset:1024 nt lds
    buffer_load_dwordx4 v3, s[16:19], s44 offen offset:2048 nt lds
    buffer_load_dwordx4 v4, s[16:19], s44 offen offset:3072 nt lds
    s_waitcnt vmcnt(40)
    s_mov_b32 m0, 28672
    s_mov_b32 s44, 163840
    buffer_load_dwordx4 v1, s[16:19], s44 offen offset:0 nt lds
    buffer_load_dwordx4 v2, s[16:19], s44 offen offset:1024 nt lds
    buffer_load_dwordx4 v3, s[16:19], s44 offen offset:2048 nt lds
    buffer_load_dwordx4 v4, s[16:19], s44 offen offset:3072 nt lds
    s_waitcnt vmcnt(40)
    s_mov_b32 m0, 32768
    s_mov_b32 s44, 167936
    buffer_load_dwordx4 v1, s[16:19], s44 offen offset:0 nt lds
    buffer_load_dwordx4 v2, s[16:19], s44 offen offset:1024 nt lds
    buffer_load_dwordx4 v3, s[16:19], s44 offen offset:2048 nt lds
    buffer_load_dwordx4 v4, s[16:19], s44 offen offset:3072 nt lds
    s_waitcnt vmcnt(40)
    s_barrier
    s_mov_b32 m0, 61440
    s_mov_b32 s44, 172032
    buffer_load_dwordx4 v1, s[16:19], s44 offen offset:0 nt lds
    buffer_load_dwordx4 v2, s[16:19], s44 offen offset:1024 nt lds
    buffer_load_dwordx4 v3, s[16:19], s44 offen offset:2048 nt lds
    buffer_load_dwordx4 v4, s[16:19], s44 offen offset:3072 nt lds
    s_waitcnt vmcnt(40)
    s_mov_b32 m0, 65536
    s_mov_b32 s44, 176128
    buffer_load_dwordx4 v1, s[16:19], s44 offen offset:0 nt lds
    buffer_load_dwordx4 v2, s[16:19], s44 offen offset:1024 nt lds
    buffer_load_dwordx4 v3, s[16:19], s44 offen offset:2048 nt lds
    buffer_load_dwordx4 v4, s[16:19], s44 offen offset:3072 nt lds
    s_waitcnt vmcnt(40)
    s_mov_b32 m0, 94208
    s_mov_b32 s44, 180224
    buffer_load_dwordx4 v1, s[16:19], s44 offen offset:0 nt lds
    buffer_load_dwordx4 v2, s[16:19], s44 offen offset:1024 nt lds
    buffer_load_dwordx4 v3, s[16:19], s44 offen offset:2048 nt lds
    buffer_load_dwordx4 v4, s[16:19], s44 offen offset:3072 nt lds
    s_waitcnt vmcnt(40)
    s_mov_b32 m0, 98304
    s_mov_b32 s44, 184320
    buffer_load_dwordx4 v1, s[16:19], s44 offen offset:0 nt lds
    buffer_load_dwordx4 v2, s[16:19], s44 offen offset:1024 nt lds
    buffer_load_dwordx4 v3, s[16:19], s44 offen offset:2048 nt lds
    buffer_load_dwordx4 v4, s[16:19], s44 offen offset:3072 nt lds
    s_waitcnt vmcnt(40)
    s_mov_b32 m0, 126976
    s_mov_b32 s44, 188416
    buffer_load_dwordx4 v1, s[16:19], s44 offen offset:0 nt lds
    buffer_load_dwordx4 v2, s[16:19], s44 offen offset:1024 nt lds
    buffer_load_dwordx4 v3, s[16:19], s44 offen offset:2048 nt lds
    buffer_load_dwordx4 v4, s[16:19], s44 offen offset:3072 nt lds
    s_waitcnt vmcnt(40)
    s_mov_b32 m0, 131072
    s_mov_b32 s44, 192512
    buffer_load_dwordx4 v1, s[16:19], s44 offen offset:0 nt lds
    buffer_load_dwordx4 v2, s[16:19], s44 offen offset:1024 nt lds
    buffer_load_dwordx4 v3, s[16:19], s44 offen offset:2048 nt lds
    buffer_load_dwordx4 v4, s[16:19], s44 offen offset:3072 nt lds
    s_waitcnt vmcnt(40)
    s_mov_b32 m0, 36864
    s_mov_b32 s44, 196608
    buffer_load_dwordx4 v1, s[16:19], s44 offen offset:0 nt lds
    buffer_load_dwordx4 v2, s[16:19], s44 offen offset:1024 nt lds
    buffer_load_dwordx4 v3, s[16:19], s44 offen offset:2048 nt lds
    buffer_load_dwordx4 v4, s[16:19], s44 offen offset:3072 nt lds
    s_waitcnt vmcnt(40)
    s_mov_b32 m0, 40960
    s_mov_b32 s44, 200704
    buffer_load_dwordx4 v1, s[16:19], s44 offen offset:0 nt lds
    buffer_load_dwordx4 v2, s[16:19], s44 offen offset:1024 nt lds
    buffer_load_dwordx4 v3, s[16:19], s44 offen offset:2048 nt lds
    buffer_load_dwordx4 v4, s[16:19], s44 offen offset:3072 nt lds
    s_waitcnt vmcnt(40)
    s_barrier
    s_mov_b32 m0, 69632
    s_mov_b32 s44, 204800
    buffer_load_dwordx4 v1, s[16:19], s44 offen offset:0 nt lds
    buffer_load_dwordx4 v2, s[16:19], s44 offen offset:1024 nt lds
    buffer_load_dwordx4 v3, s[16:19], s44 offen offset:2048 nt lds
    buffer_load_dwordx4 v4, s[16:19], s44 offen offset:3072 nt lds
    s_waitcnt vmcnt(40)
    s_mov_b32 m0, 73728
    s_mov_b32 s44, 208896
    buffer_load_dwordx4 v1, s[16:19], s44 offen offset:0 nt lds
    buffer_load_dwordx4 v2, s[16:19], s44 offen offset:1024 nt lds
    buffer_load_dwordx4 v3, s[16:19], s44 offen offset:2048 nt lds
    buffer_load_dwordx4 v4, s[16:19], s44 offen offset:3072 nt lds
    s_waitcnt vmcnt(40)
    s_mov_b32 m0, 102400
    s_mov_b32 s44, 212992
    buffer_load_dwordx4 v1, s[16:19], s44 offen offset:0 nt lds
    buffer_load_dwordx4 v2, s[16:19], s44 offen offset:1024 nt lds
    buffer_load_dwordx4 v3, s[16:19], s44 offen offset:2048 nt lds
    buffer_load_dwordx4 v4, s[16:19], s44 offen offset:3072 nt lds
    s_waitcnt vmcnt(40)
    s_mov_b32 m0, 106496
    s_mov_b32 s44, 217088
    buffer_load_dwordx4 v1, s[16:19], s44 offen offset:0 nt lds
    buffer_load_dwordx4 v2, s[16:19], s44 offen offset:1024 nt lds
    buffer_load_dwordx4 v3, s[16:19], s44 offen offset:2048 nt lds
    buffer_load_dwordx4 v4, s[16:19], s44 offen offset:3072 nt lds
    s_waitcnt vmcnt(40)
    s_mov_b32 m0, 135168
    s_mov_b32 s44, 221184
    buffer_load_dwordx4 v1, s[16:19], s44 offen offset:0 nt lds
    buffer_load_dwordx4 v2, s[16:19], s44 offen offset:1024 nt lds
    buffer_load_dwordx4 v3, s[16:19], s44 offen offset:2048 nt lds
    buffer_load_dwordx4 v4, s[16:19], s44 offen offset:3072 nt lds
    s_waitcnt vmcnt(40)
    s_mov_b32 m0, 139264
    s_mov_b32 s44, 225280
    buffer_load_dwordx4 v1, s[16:19], s44 offen offset:0 nt lds
    buffer_load_dwordx4 v2, s[16:19], s44 offen offset:1024 nt lds
    buffer_load_dwordx4 v3, s[16:19], s44 offen offset:2048 nt lds
    buffer_load_dwordx4 v4, s[16:19], s44 offen offset:3072 nt lds
    s_waitcnt vmcnt(40)
    s_mov_b32 m0, 45056
    s_mov_b32 s44, 229376
    buffer_load_dwordx4 v1, s[16:19], s44 offen offset:0 nt lds
    buffer_load_dwordx4 v2, s[16:19], s44 offen offset:1024 nt lds
    buffer_load_dwordx4 v3, s[16:19], s44 offen offset:2048 nt lds
    buffer_load_dwordx4 v4, s[16:19], s44 offen offset:3072 nt lds
    s_waitcnt vmcnt(40)
    s_mov_b32 m0, 49152
    s_mov_b32 s44, 233472
    buffer_load_dwordx4 v1, s[16:19], s44 offen offset:0 nt lds
    buffer_load_dwordx4 v2, s[16:19], s44 offen offset:1024 nt lds
    buffer_load_dwordx4 v3, s[16:19], s44 offen offset:2048 nt lds
    buffer_load_dwordx4 v4, s[16:19], s44 offen offset:3072 nt lds
    s_waitcnt vmcnt(40)
    s_barrier
    s_mov_b32 m0, 77824
    s_mov_b32 s44, 237568
    buffer_load_dwordx4 v1, s[16:19], s44 offen offset:0 nt lds
    buffer_load_dwordx4 v2, s[16:19], s44 offen offset:1024 nt lds
    buffer_load_dwordx4 v3, s[16:19], s44 offen offset:2048 nt lds
    buffer_load_dwordx4 v4, s[16:19], s44 offen offset:3072 nt lds
    s_waitcnt vmcnt(40)
    s_mov_b32 m0, 81920
    s_mov_b32 s44, 241664
    buffer_load_dwordx4 v1, s[16:19], s44 offen offset:0 nt lds
    buffer_load_dwordx4 v2, s[16:19], s44 offen offset:1024 nt lds
    buffer_load_dwordx4 v3, s[16:19], s44 offen offset:2048 nt lds
    buffer_load_dwordx4 v4, s[16:19], s44 offen offset:3072 nt lds
    s_waitcnt vmcnt(40)
    s_mov_b32 m0, 110592
    s_mov_b32 s44, 245760
    buffer_load_dwordx4 v1, s[16:19], s44 offen offset:0 nt lds
    buffer_load_dwordx4 v2, s[16:19], s44 offen offset:1024 nt lds
    buffer_load_dwordx4 v3, s[16:19], s44 offen offset:2048 nt lds
    buffer_load_dwordx4 v4, s[16:19], s44 offen offset:3072 nt lds
    s_waitcnt vmcnt(40)
    s_mov_b32 m0, 114688
    s_mov_b32 s44, 249856
    buffer_load_dwordx4 v1, s[16:19], s44 offen offset:0 nt lds
    buffer_load_dwordx4 v2, s[16:19], s44 offen offset:1024 nt lds
    buffer_load_dwordx4 v3, s[16:19], s44 offen offset:2048 nt lds
    buffer_load_dwordx4 v4, s[16:19], s44 offen offset:3072 nt lds
    s_waitcnt vmcnt(40)
    s_mov_b32 m0, 143360
    s_mov_b32 s44, 253952
    buffer_load_dwordx4 v1, s[16:19], s44 offen offset:0 nt lds
    buffer_load_dwordx4 v2, s[16:19], s44 offen offset:1024 nt lds
    buffer_load_dwordx4 v3, s[16:19], s44 offen offset:2048 nt lds
    buffer_load_dwordx4 v4, s[16:19], s44 offen offset:3072 nt lds
    s_waitcnt vmcnt(40)
    s_mov_b32 m0, 147456
    s_mov_b32 s44, 258048
    buffer_load_dwordx4 v1, s[16:19], s44 offen offset:0 nt lds
    buffer_load_dwordx4 v2, s[16:19], s44 offen offset:1024 nt lds
    buffer_load_dwordx4 v3, s[16:19], s44 offen offset:2048 nt lds
    buffer_load_dwordx4 v4, s[16:19], s44 offen offset:3072 nt lds
    s_waitcnt vmcnt(40)
    s_mov_b32 m0, 20480
    s_mov_b32 s44, 0
    buffer_load_dwordx4 v5, s[20:23], s44 offen offset:0 nt lds
    buffer_load_dwordx4 v5, s[20:23], s44 offen offset:1024 nt lds
    buffer_load_dwordx4 v5, s[20:23], s44 offen offset:2048 nt lds
    buffer_load_dwordx4 v5, s[20:23], s44 offen offset:3072 nt lds
    s_waitcnt vmcnt(40)
    s_mov_b32 m0, 24576
    s_mov_b32 s44, 4096
    buffer_load_dwordx4 v5, s[20:23], s44 offen offset:0 nt lds
    buffer_load_dwordx4 v5, s[20:23], s44 offen offset:1024 nt lds
    buffer_load_dwordx4 v5, s[20:23], s44 offen offset:2048 nt lds
    buffer_load_dwordx4 v5, s[20:23], s44 offen offset:3072 nt lds
    s_waitcnt vmcnt(40)
    s_barrier
    s_mov_b32 m0, 53248
    s_mov_b32 s44, 8192
    buffer_load_dwordx4 v5, s[20:23], s44 offen offset:0 nt lds
    buffer_load_dwordx4 v5, s[20:23], s44 offen offset:1024 nt lds
    buffer_load_dwordx4 v5, s[20:23], s44 offen offset:2048 nt lds
    buffer_load_dwordx4 v5, s[20:23], s44 offen offset:3072 nt lds
    s_waitcnt vmcnt(40)
    s_mov_b32 m0, 57344
    s_mov_b32 s44, 12288
    buffer_load_dwordx4 v5, s[20:23], s44 offen offset:0 nt lds
    buffer_load_dwordx4 v5, s[20:23], s44 offen offset:1024 nt lds
    buffer_load_dwordx4 v5, s[20:23], s44 offen offset:2048 nt lds
    buffer_load_dwordx4 v5, s[20:23], s44 offen offset:3072 nt lds
    s_waitcnt vmcnt(40)
    s_mov_b32 m0, 86016
    s_mov_b32 s44, 16384
    buffer_load_dwordx4 v5, s[20:23], s44 offen offset:0 nt lds
    buffer_load_dwordx4 v5, s[20:23], s44 offen offset:1024 nt lds
    buffer_load_dwordx4 v5, s[20:23], s44 offen offset:2048 nt lds
    buffer_load_dwordx4 v5, s[20:23], s44 offen offset:3072 nt lds
    s_waitcnt vmcnt(40)
    s_mov_b32 m0, 90112
    s_mov_b32 s44, 20480
    buffer_load_dwordx4 v5, s[20:23], s44 offen offset:0 nt lds
    buffer_load_dwordx4 v5, s[20:23], s44 offen offset:1024 nt lds
    buffer_load_dwordx4 v5, s[20:23], s44 offen offset:2048 nt lds
    buffer_load_dwordx4 v5, s[20:23], s44 offen offset:3072 nt lds
    s_waitcnt vmcnt(40)
    s_mov_b32 m0, 118784
    s_mov_b32 s44, 24576
    buffer_load_dwordx4 v5, s[20:23], s44 offen offset:0 nt lds
    buffer_load_dwordx4 v5, s[20:23], s44 offen offset:1024 nt lds
    buffer_load_dwordx4 v5, s[20:23], s44 offen offset:2048 nt lds
    buffer_load_dwordx4 v5, s[20:23], s44 offen offset:3072 nt lds
    s_waitcnt vmcnt(40)
    s_mov_b32 m0, 122880
    s_mov_b32 s44, 28672
    buffer_load_dwordx4 v5, s[20:23], s44 offen offset:0 nt lds
    buffer_load_dwordx4 v5, s[20:23], s44 offen offset:1024 nt lds
    buffer_load_dwordx4 v5, s[20:23], s44 offen offset:2048 nt lds
    buffer_load_dwordx4 v5, s[20:23], s44 offen offset:3072 nt lds
    s_waitcnt vmcnt(40)
    s_mov_b32 m0, 28672
    s_mov_b32 s44, 32768
    buffer_load_dwordx4 v5, s[20:23], s44 offen offset:0 nt lds
    buffer_load_dwordx4 v5, s[20:23], s44 offen offset:1024 nt lds
    buffer_load_dwordx4 v5, s[20:23], s44 offen offset:2048 nt lds
    buffer_load_dwordx4 v5, s[20:23], s44 offen offset:3072 nt lds
    s_waitcnt vmcnt(40)
    s_mov_b32 m0, 32768
    s_mov_b32 s44, 36864
    buffer_load_dwordx4 v5, s[20:23], s44 offen offset:0 nt lds
    buffer_load_dwordx4 v5, s[20:23], s44 offen offset:1024 nt lds
    buffer_load_dwordx4 v5, s[20:23], s44 offen offset:2048 nt lds
    buffer_load_dwordx4 v5, s[20:23], s44 offen offset:3072 nt lds
    s_waitcnt vmcnt(40)
    s_barrier
    s_mov_b32 m0, 61440
    s_mov_b32 s44, 40960
    buffer_load_dwordx4 v5, s[20:23], s44 offen offset:0 nt lds
    buffer_load_dwordx4 v5, s[20:23], s44 offen offset:1024 nt lds
    buffer_load_dwordx4 v5, s[20:23], s44 offen offset:2048 nt lds
    buffer_load_dwordx4 v5, s[20:23], s44 offen offset:3072 nt lds
    s_waitcnt vmcnt(40)
    s_mov_b32 m0, 65536
    s_mov_b32 s44, 45056
    buffer_load_dwordx4 v5, s[20:23], s44 offen offset:0 nt lds
    buffer_load_dwordx4 v5, s[20:23], s44 offen offset:1024 nt lds
    buffer_load_dwordx4 v5, s[20:23], s44 offen offset:2048 nt lds
    buffer_load_dwordx4 v5, s[20:23], s44 offen offset:3072 nt lds
    s_waitcnt vmcnt(40)
    s_mov_b32 m0, 94208
    s_mov_b32 s44, 49152
    buffer_load_dwordx4 v5, s[20:23], s44 offen offset:0 nt lds
    buffer_load_dwordx4 v5, s[20:23], s44 offen offset:1024 nt lds
    buffer_load_dwordx4 v5, s[20:23], s44 offen offset:2048 nt lds
    buffer_load_dwordx4 v5, s[20:23], s44 offen offset:3072 nt lds
    s_waitcnt vmcnt(40)
    s_mov_b32 m0, 98304
    s_mov_b32 s44, 53248
    buffer_load_dwordx4 v5, s[20:23], s44 offen offset:0 nt lds
    buffer_load_dwordx4 v5, s[20:23], s44 offen offset:1024 nt lds
    buffer_load_dwordx4 v5, s[20:23], s44 offen offset:2048 nt lds
    buffer_load_dwordx4 v5, s[20:23], s44 offen offset:3072 nt lds
    s_waitcnt vmcnt(40)
    s_barrier
    s_mov_b32 m0, 126976
    s_mov_b32 s44, 57344
    buffer_load_dwordx4 v5, s[20:23], s44 offen offset:0 nt lds
    buffer_load_dwordx4 v5, s[20:23], s44 offen offset:1024 nt lds
    buffer_load_dwordx4 v5, s[20:23], s44 offen offset:2048 nt lds
    buffer_load_dwordx4 v5, s[20:23], s44 offen offset:3072 nt lds
    s_waitcnt vmcnt(40)
    s_mov_b32 m0, 131072
    s_mov_b32 s44, 61440
    buffer_load_dwordx4 v5, s[20:23], s44 offen offset:0 nt lds
    buffer_load_dwordx4 v5, s[20:23], s44 offen offset:1024 nt lds
    buffer_load_dwordx4 v5, s[20:23], s44 offen offset:2048 nt lds
    buffer_load_dwordx4 v5, s[20:23], s44 offen offset:3072 nt lds
    s_waitcnt vmcnt(40)
    s_barrier
    s_mov_b32 m0, 36864
    s_mov_b32 s44, 65536
    buffer_load_dwordx4 v5, s[20:23], s44 offen offset:0 nt lds
    buffer_load_dwordx4 v5, s[20:23], s44 offen offset:1024 nt lds
    buffer_load_dwordx4 v5, s[20:23], s44 offen offset:2048 nt lds
    buffer_load_dwordx4 v5, s[20:23], s44 offen offset:3072 nt lds
    s_waitcnt vmcnt(40)
    s_mov_b32 m0, 40960
    s_mov_b32 s44, 69632
    buffer_load_dwordx4 v5, s[20:23], s44 offen offset:0 nt lds
    buffer_load_dwordx4 v5, s[20:23], s44 offen offset:1024 nt lds
    buffer_load_dwordx4 v5, s[20:23], s44 offen offset:2048 nt lds
    buffer_load_dwordx4 v5, s[20:23], s44 offen offset:3072 nt lds
    s_waitcnt vmcnt(40)
    s_barrier
    s_mov_b32 m0, 69632
    s_mov_b32 s44, 73728
    buffer_load_dwordx4 v5, s[20:23], s44 offen offset:0 nt lds
    buffer_load_dwordx4 v5, s[20:23], s44 offen offset:1024 nt lds
    buffer_load_dwordx4 v5, s[20:23], s44 offen offset:2048 nt lds
    buffer_load_dwordx4 v5, s[20:23], s44 offen offset:3072 nt lds
    s_waitcnt vmcnt(40)
    s_mov_b32 m0, 73728
    s_mov_b32 s44, 77824
    buffer_load_dwordx4 v5, s[20:23], s44 offen offset:0 nt lds
    buffer_load_dwordx4 v5, s[20:23], s44 offen offset:1024 nt lds
    buffer_load_dwordx4 v5, s[20:23], s44 offen offset:2048 nt lds
    buffer_load_dwordx4 v5, s[20:23], s44 offen offset:3072 nt lds
    s_waitcnt vmcnt(40)
    s_mov_b32 m0, 102400
    s_mov_b32 s44, 81920
    buffer_load_dwordx4 v5, s[20:23], s44 offen offset:0 nt lds
    buffer_load_dwordx4 v5, s[20:23], s44 offen offset:1024 nt lds
    buffer_load_dwordx4 v5, s[20:23], s44 offen offset:2048 nt lds
    buffer_load_dwordx4 v5, s[20:23], s44 offen offset:3072 nt lds
    s_waitcnt vmcnt(40)
    s_mov_b32 m0, 106496
    s_mov_b32 s44, 86016
    buffer_load_dwordx4 v5, s[20:23], s44 offen offset:0 nt lds
    buffer_load_dwordx4 v5, s[20:23], s44 offen offset:1024 nt lds
    buffer_load_dwordx4 v5, s[20:23], s44 offen offset:2048 nt lds
    buffer_load_dwordx4 v5, s[20:23], s44 offen offset:3072 nt lds
    s_waitcnt vmcnt(40)
    s_mov_b32 m0, 135168
    s_mov_b32 s44, 90112
    buffer_load_dwordx4 v5, s[20:23], s44 offen offset:0 nt lds
    buffer_load_dwordx4 v5, s[20:23], s44 offen offset:1024 nt lds
    buffer_load_dwordx4 v5, s[20:23], s44 offen offset:2048 nt lds
    buffer_load_dwordx4 v5, s[20:23], s44 offen offset:3072 nt lds
    s_waitcnt vmcnt(40)
    s_mov_b32 m0, 139264
    s_mov_b32 s44, 94208
    buffer_load_dwordx4 v5, s[20:23], s44 offen offset:0 nt lds
    buffer_load_dwordx4 v5, s[20:23], s44 offen offset:1024 nt lds
    buffer_load_dwordx4 v5, s[20:23], s44 offen offset:2048 nt lds
    buffer_load_dwordx4 v5, s[20:23], s44 offen offset:3072 nt lds
    s_waitcnt vmcnt(40)
    s_mov_b32 m0, 45056
    s_mov_b32 s44, 98304
    buffer_load_dwordx4 v5, s[20:23], s44 offen offset:0 nt lds
    buffer_load_dwordx4 v5, s[20:23], s44 offen offset:1024 nt lds
    buffer_load_dwordx4 v5, s[20:23], s44 offen offset:2048 nt lds
    buffer_load_dwordx4 v5, s[20:23], s44 offen offset:3072 nt lds
    s_waitcnt vmcnt(40)
    s_mov_b32 m0, 49152
    s_mov_b32 s44, 102400
    buffer_load_dwordx4 v5, s[20:23], s44 offen offset:0 nt lds
    buffer_load_dwordx4 v5, s[20:23], s44 offen offset:1024 nt lds
    buffer_load_dwordx4 v5, s[20:23], s44 offen offset:2048 nt lds
    buffer_load_dwordx4 v5, s[20:23], s44 offen offset:3072 nt lds
    s_waitcnt vmcnt(40)
    s_barrier
    s_mov_b32 m0, 77824
    s_mov_b32 s44, 106496
    buffer_load_dwordx4 v5, s[20:23], s44 offen offset:0 nt lds
    buffer_load_dwordx4 v5, s[20:23], s44 offen offset:1024 nt lds
    buffer_load_dwordx4 v5, s[20:23], s44 offen offset:2048 nt lds
    buffer_load_dwordx4 v5, s[20:23], s44 offen offset:3072 nt lds
    s_waitcnt vmcnt(40)
    s_mov_b32 m0, 81920
    s_mov_b32 s44, 110592
    buffer_load_dwordx4 v5, s[20:23], s44 offen offset:0 nt lds
    buffer_load_dwordx4 v5, s[20:23], s44 offen offset:1024 nt lds
    buffer_load_dwordx4 v5, s[20:23], s44 offen offset:2048 nt lds
    buffer_load_dwordx4 v5, s[20:23], s44 offen offset:3072 nt lds
    s_waitcnt vmcnt(40)
    s_mov_b32 m0, 110592
    s_mov_b32 s44, 114688
    buffer_load_dwordx4 v5, s[20:23], s44 offen offset:0 nt lds
    buffer_load_dwordx4 v5, s[20:23], s44 offen offset:1024 nt lds
    buffer_load_dwordx4 v5, s[20:23], s44 offen offset:2048 nt lds
    buffer_load_dwordx4 v5, s[20:23], s44 offen offset:3072 nt lds
    s_waitcnt vmcnt(40)
    s_mov_b32 m0, 114688
    s_mov_b32 s44, 118784
    buffer_load_dwordx4 v5, s[20:23], s44 offen offset:0 nt lds
    buffer_load_dwordx4 v5, s[20:23], s44 offen offset:1024 nt lds
    buffer_load_dwordx4 v5, s[20:23], s44 offen offset:2048 nt lds
    buffer_load_dwordx4 v5, s[20:23], s44 offen offset:3072 nt lds
    s_waitcnt vmcnt(40)
    s_mov_b32 m0, 143360
    s_mov_b32 s44, 122880
    buffer_load_dwordx4 v5, s[20:23], s44 offen offset:0 nt lds
    buffer_load_dwordx4 v5, s[20:23], s44 offen offset:1024 nt lds
    buffer_load_dwordx4 v5, s[20:23], s44 offen offset:2048 nt lds
    buffer_load_dwordx4 v5, s[20:23], s44 offen offset:3072 nt lds
    s_waitcnt vmcnt(40)
    s_mov_b32 m0, 147456
    s_mov_b32 s44, 126976
    buffer_load_dwordx4 v5, s[20:23], s44 offen offset:0 nt lds
    buffer_load_dwordx4 v5, s[20:23], s44 offen offset:1024 nt lds
    buffer_load_dwordx4 v5, s[20:23], s44 offen offset:2048 nt lds
    buffer_load_dwordx4 v5, s[20:23], s44 offen offset:3072 nt lds
    s_waitcnt vmcnt(40)
    s_mov_b32 m0, 20480
    s_mov_b32 s44, 131072
    buffer_load_dwordx4 v5, s[20:23], s44 offen offset:0 nt lds
    buffer_load_dwordx4 v5, s[20:23], s44 offen offset:1024 nt lds
    buffer_load_dwordx4 v5, s[20:23], s44 offen offset:2048 nt lds
    buffer_load_dwordx4 v5, s[20:23], s44 offen offset:3072 nt lds
    s_waitcnt vmcnt(40)
    s_mov_b32 m0, 24576
    s_mov_b32 s44, 135168
    buffer_load_dwordx4 v5, s[20:23], s44 offen offset:0 nt lds
    buffer_load_dwordx4 v5, s[20:23], s44 offen offset:1024 nt lds
    buffer_load_dwordx4 v5, s[20:23], s44 offen offset:2048 nt lds
    buffer_load_dwordx4 v5, s[20:23], s44 offen offset:3072 nt lds
    s_waitcnt vmcnt(40)
    s_barrier
    s_mov_b32 m0, 53248
    s_mov_b32 s44, 139264
    buffer_load_dwordx4 v5, s[20:23], s44 offen offset:0 nt lds
    buffer_load_dwordx4 v5, s[20:23], s44 offen offset:1024 nt lds
    buffer_load_dwordx4 v5, s[20:23], s44 offen offset:2048 nt lds
    buffer_load_dwordx4 v5, s[20:23], s44 offen offset:3072 nt lds
    s_waitcnt vmcnt(40)
    s_mov_b32 m0, 57344
    s_mov_b32 s44, 143360
    buffer_load_dwordx4 v5, s[20:23], s44 offen offset:0 nt lds
    buffer_load_dwordx4 v5, s[20:23], s44 offen offset:1024 nt lds
    buffer_load_dwordx4 v5, s[20:23], s44 offen offset:2048 nt lds
    buffer_load_dwordx4 v5, s[20:23], s44 offen offset:3072 nt lds
    s_waitcnt vmcnt(40)
    s_mov_b32 m0, 86016
    s_mov_b32 s44, 147456
    buffer_load_dwordx4 v5, s[20:23], s44 offen offset:0 nt lds
    buffer_load_dwordx4 v5, s[20:23], s44 offen offset:1024 nt lds
    buffer_load_dwordx4 v5, s[20:23], s44 offen offset:2048 nt lds
    buffer_load_dwordx4 v5, s[20:23], s44 offen offset:3072 nt lds
    s_waitcnt vmcnt(40)
    s_mov_b32 m0, 90112
    s_mov_b32 s44, 151552
    buffer_load_dwordx4 v5, s[20:23], s44 offen offset:0 nt lds
    buffer_load_dwordx4 v5, s[20:23], s44 offen offset:1024 nt lds
    buffer_load_dwordx4 v5, s[20:23], s44 offen offset:2048 nt lds
    buffer_load_dwordx4 v5, s[20:23], s44 offen offset:3072 nt lds
    s_waitcnt vmcnt(40)
    s_mov_b32 m0, 118784
    s_mov_b32 s44, 155648
    buffer_load_dwordx4 v5, s[20:23], s44 offen offset:0 nt lds
    buffer_load_dwordx4 v5, s[20:23], s44 offen offset:1024 nt lds
    buffer_load_dwordx4 v5, s[20:23], s44 offen offset:2048 nt lds
    buffer_load_dwordx4 v5, s[20:23], s44 offen offset:3072 nt lds
    s_waitcnt vmcnt(40)
    s_mov_b32 m0, 122880
    s_mov_b32 s44, 159744
    buffer_load_dwordx4 v5, s[20:23], s44 offen offset:0 nt lds
    buffer_load_dwordx4 v5, s[20:23], s44 offen offset:1024 nt lds
    buffer_load_dwordx4 v5, s[20:23], s44 offen offset:2048 nt lds
    buffer_load_dwordx4 v5, s[20:23], s44 offen offset:3072 nt lds
    s_waitcnt vmcnt(40)
    s_mov_b32 m0, 28672
    s_mov_b32 s44, 163840
    buffer_load_dwordx4 v5, s[20:23], s44 offen offset:0 nt lds
    buffer_load_dwordx4 v5, s[20:23], s44 offen offset:1024 nt lds
    buffer_load_dwordx4 v5, s[20:23], s44 offen offset:2048 nt lds
    buffer_load_dwordx4 v5, s[20:23], s44 offen offset:3072 nt lds
    s_waitcnt vmcnt(40)
    s_mov_b32 m0, 32768
    s_mov_b32 s44, 167936
    buffer_load_dwordx4 v5, s[20:23], s44 offen offset:0 nt lds
    buffer_load_dwordx4 v5, s[20:23], s44 offen offset:1024 nt lds
    buffer_load_dwordx4 v5, s[20:23], s44 offen offset:2048 nt lds
    buffer_load_dwordx4 v5, s[20:23], s44 offen offset:3072 nt lds
    s_waitcnt vmcnt(40)
    s_barrier
    s_mov_b32 m0, 61440
    s_mov_b32 s44, 172032
    buffer_load_dwordx4 v5, s[20:23], s44 offen offset:0 nt lds
    buffer_load_dwordx4 v5, s[20:23], s44 offen offset:1024 nt lds
    buffer_load_dwordx4 v5, s[20:23], s44 offen offset:2048 nt lds
    buffer_load_dwordx4 v5, s[20:23], s44 offen offset:3072 nt lds
    s_waitcnt vmcnt(40)
    s_mov_b32 m0, 65536
    s_mov_b32 s44, 176128
    buffer_load_dwordx4 v5, s[20:23], s44 offen offset:0 nt lds
    buffer_load_dwordx4 v5, s[20:23], s44 offen offset:1024 nt lds
    buffer_load_dwordx4 v5, s[20:23], s44 offen offset:2048 nt lds
    buffer_load_dwordx4 v5, s[20:23], s44 offen offset:3072 nt lds
    s_waitcnt vmcnt(40)
    s_mov_b32 m0, 94208
    s_mov_b32 s44, 180224
    buffer_load_dwordx4 v5, s[20:23], s44 offen offset:0 nt lds
    buffer_load_dwordx4 v5, s[20:23], s44 offen offset:1024 nt lds
    buffer_load_dwordx4 v5, s[20:23], s44 offen offset:2048 nt lds
    buffer_load_dwordx4 v5, s[20:23], s44 offen offset:3072 nt lds
    s_waitcnt vmcnt(40)
    s_mov_b32 m0, 98304
    s_mov_b32 s44, 184320
    buffer_load_dwordx4 v5, s[20:23], s44 offen offset:0 nt lds
    buffer_load_dwordx4 v5, s[20:23], s44 offen offset:1024 nt lds
    buffer_load_dwordx4 v5, s[20:23], s44 offen offset:2048 nt lds
    buffer_load_dwordx4 v5, s[20:23], s44 offen offset:3072 nt lds
    s_waitcnt vmcnt(40)
    s_mov_b32 m0, 126976
    s_mov_b32 s44, 188416
    buffer_load_dwordx4 v5, s[20:23], s44 offen offset:0 nt lds
    buffer_load_dwordx4 v5, s[20:23], s44 offen offset:1024 nt lds
    buffer_load_dwordx4 v5, s[20:23], s44 offen offset:2048 nt lds
    buffer_load_dwordx4 v5, s[20:23], s44 offen offset:3072 nt lds
    s_waitcnt vmcnt(40)
    s_mov_b32 m0, 131072
    s_mov_b32 s44, 192512
    buffer_load_dwordx4 v5, s[20:23], s44 offen offset:0 nt lds
    buffer_load_dwordx4 v5, s[20:23], s44 offen offset:1024 nt lds
    buffer_load_dwordx4 v5, s[20:23], s44 offen offset:2048 nt lds
    buffer_load_dwordx4 v5, s[20:23], s44 offen offset:3072 nt lds
    s_waitcnt vmcnt(40)
    s_mov_b32 m0, 36864
    s_mov_b32 s44, 196608
    buffer_load_dwordx4 v5, s[20:23], s44 offen offset:0 nt lds
    buffer_load_dwordx4 v5, s[20:23], s44 offen offset:1024 nt lds
    buffer_load_dwordx4 v5, s[20:23], s44 offen offset:2048 nt lds
    buffer_load_dwordx4 v5, s[20:23], s44 offen offset:3072 nt lds
    s_waitcnt vmcnt(40)
    s_mov_b32 m0, 40960
    s_mov_b32 s44, 200704
    buffer_load_dwordx4 v5, s[20:23], s44 offen offset:0 nt lds
    buffer_load_dwordx4 v5, s[20:23], s44 offen offset:1024 nt lds
    buffer_load_dwordx4 v5, s[20:23], s44 offen offset:2048 nt lds
    buffer_load_dwordx4 v5, s[20:23], s44 offen offset:3072 nt lds
    s_waitcnt vmcnt(40)
    s_barrier
    s_mov_b32 m0, 69632
    s_mov_b32 s44, 204800
    buffer_load_dwordx4 v5, s[20:23], s44 offen offset:0 nt lds
    buffer_load_dwordx4 v5, s[20:23], s44 offen offset:1024 nt lds
    buffer_load_dwordx4 v5, s[20:23], s44 offen offset:2048 nt lds
    buffer_load_dwordx4 v5, s[20:23], s44 offen offset:3072 nt lds
    s_waitcnt vmcnt(40)
    s_mov_b32 m0, 73728
    s_mov_b32 s44, 208896
    buffer_load_dwordx4 v5, s[20:23], s44 offen offset:0 nt lds
    buffer_load_dwordx4 v5, s[20:23], s44 offen offset:1024 nt lds
    buffer_load_dwordx4 v5, s[20:23], s44 offen offset:2048 nt lds
    buffer_load_dwordx4 v5, s[20:23], s44 offen offset:3072 nt lds
    s_waitcnt vmcnt(40)
    s_mov_b32 m0, 102400
    s_mov_b32 s44, 212992
    buffer_load_dwordx4 v5, s[20:23], s44 offen offset:0 nt lds
    buffer_load_dwordx4 v5, s[20:23], s44 offen offset:1024 nt lds
    buffer_load_dwordx4 v5, s[20:23], s44 offen offset:2048 nt lds
    buffer_load_dwordx4 v5, s[20:23], s44 offen offset:3072 nt lds
    s_waitcnt vmcnt(40)
    s_mov_b32 m0, 106496
    s_mov_b32 s44, 217088
    buffer_load_dwordx4 v5, s[20:23], s44 offen offset:0 nt lds
    buffer_load_dwordx4 v5, s[20:23], s44 offen offset:1024 nt lds
    buffer_load_dwordx4 v5, s[20:23], s44 offen offset:2048 nt lds
    buffer_load_dwordx4 v5, s[20:23], s44 offen offset:3072 nt lds
    s_waitcnt vmcnt(40)
    s_mov_b32 m0, 135168
    s_mov_b32 s44, 221184
    buffer_load_dwordx4 v5, s[20:23], s44 offen offset:0 nt lds
    buffer_load_dwordx4 v5, s[20:23], s44 offen offset:1024 nt lds
    buffer_load_dwordx4 v5, s[20:23], s44 offen offset:2048 nt lds
    buffer_load_dwordx4 v5, s[20:23], s44 offen offset:3072 nt lds
    s_waitcnt vmcnt(40)
    s_mov_b32 m0, 139264
    s_mov_b32 s44, 225280
    buffer_load_dwordx4 v5, s[20:23], s44 offen offset:0 nt lds
    buffer_load_dwordx4 v5, s[20:23], s44 offen offset:1024 nt lds
    buffer_load_dwordx4 v5, s[20:23], s44 offen offset:2048 nt lds
    buffer_load_dwordx4 v5, s[20:23], s44 offen offset:3072 nt lds
    s_waitcnt vmcnt(40)
    s_mov_b32 m0, 45056
    s_mov_b32 s44, 229376
    buffer_load_dwordx4 v5, s[20:23], s44 offen offset:0 nt lds
    buffer_load_dwordx4 v5, s[20:23], s44 offen offset:1024 nt lds
    buffer_load_dwordx4 v5, s[20:23], s44 offen offset:2048 nt lds
    buffer_load_dwordx4 v5, s[20:23], s44 offen offset:3072 nt lds
    s_waitcnt vmcnt(40)
    s_mov_b32 m0, 77824
    s_mov_b32 s44, 237568
    buffer_load_dwordx4 v5, s[20:23], s44 offen offset:0 nt lds
    buffer_load_dwordx4 v5, s[20:23], s44 offen offset:1024 nt lds
    buffer_load_dwordx4 v5, s[20:23], s44 offen offset:2048 nt lds
    buffer_load_dwordx4 v5, s[20:23], s44 offen offset:3072 nt lds
    s_waitcnt vmcnt(40)
    s_barrier
    s_mov_b32 m0, 110592
    s_mov_b32 s44, 245760
    buffer_load_dwordx4 v5, s[20:23], s44 offen offset:0 nt lds
    buffer_load_dwordx4 v5, s[20:23], s44 offen offset:1024 nt lds
    buffer_load_dwordx4 v5, s[20:23], s44 offen offset:2048 nt lds
    buffer_load_dwordx4 v5, s[20:23], s44 offen offset:3072 nt lds
    s_waitcnt vmcnt(40)
    s_mov_b32 m0, 143360
    s_mov_b32 s44, 253952
    buffer_load_dwordx4 v5, s[20:23], s44 offen offset:0 nt lds
    buffer_load_dwordx4 v5, s[20:23], s44 offen offset:1024 nt lds
    buffer_load_dwordx4 v5, s[20:23], s44 offen offset:2048 nt lds
    buffer_load_dwordx4 v5, s[20:23], s44 offen offset:3072 nt lds
    s_waitcnt vmcnt(40)
    s_mov_b32 m0, 49152
    s_mov_b32 s44, 233472
    buffer_load_dwordx4 v5, s[20:23], s44 offen offset:0 nt lds
    buffer_load_dwordx4 v5, s[20:23], s44 offen offset:1024 nt lds
    buffer_load_dwordx4 v5, s[20:23], s44 offen offset:2048 nt lds
    buffer_load_dwordx4 v5, s[20:23], s44 offen offset:3072 nt lds
    s_waitcnt vmcnt(40)
    s_mov_b32 m0, 81920
    s_mov_b32 s44, 241664
    buffer_load_dwordx4 v5, s[20:23], s44 offen offset:0 nt lds
    buffer_load_dwordx4 v5, s[20:23], s44 offen offset:1024 nt lds
    buffer_load_dwordx4 v5, s[20:23], s44 offen offset:2048 nt lds
    buffer_load_dwordx4 v5, s[20:23], s44 offen offset:3072 nt lds
    s_waitcnt vmcnt(40)
    s_mov_b32 m0, 114688
    s_mov_b32 s44, 249856
    buffer_load_dwordx4 v5, s[20:23], s44 offen offset:0 nt lds
    buffer_load_dwordx4 v5, s[20:23], s44 offen offset:1024 nt lds
    buffer_load_dwordx4 v5, s[20:23], s44 offen offset:2048 nt lds
    buffer_load_dwordx4 v5, s[20:23], s44 offen offset:3072 nt lds
    s_waitcnt vmcnt(40)
    s_mov_b32 m0, 147456
    s_mov_b32 s44, 258048
    buffer_load_dwordx4 v5, s[20:23], s44 offen offset:0 nt lds
    buffer_load_dwordx4 v5, s[20:23], s44 offen offset:1024 nt lds
    buffer_load_dwordx4 v5, s[20:23], s44 offen offset:2048 nt lds
    buffer_load_dwordx4 v5, s[20:23], s44 offen offset:3072 nt lds
    s_waitcnt vmcnt(32)
    s_barrier
    s_waitcnt vmcnt(16)
    s_barrier
    s_waitcnt vmcnt(0)
    s_barrier
    s_endpgm
L_compute:
    v_lshrrev_b32 v244, 5, v0
    v_and_b32 v245, 31, v0
    v_xor_b32 v246, v244, v7
    v_lshlrev_b32 v246, 4, v246
    v_bfe_u32 v247, v0, 2, 2
    v_lshl_add_u32 v248, v244, 2, v247
    v_xor_b32 v249, s36, v247
    v_lshlrev_b32 v249, 6, v249
    v_lshl_add_u32 v249, v248, 8, v249
    v_and_b32 v250, 1, v6
    v_lshl_add_u32 v249, v250, 5, v249
    v_and_b32 v250, 3, v0
    v_lshl_add_u32 v249, v250, 3, v249
    v_add_u32 v14, s37, v249
    s_xor_b32 s41, s36, 1
    s_lshl_b32 s41, s41, 15
    s_add_u32 s41, s41, 20480
    v_add_u32 v15, s41, v249
    s_xor_b32 s41, s36, 2
    s_lshl_b32 s41, s41, 15
    s_add_u32 s41, s41, 20480
    v_add_u32 v16, s41, v249
    s_xor_b32 s41, s36, 3
    s_lshl_b32 s41, s41, 15
    s_add_u32 s41, s41, 20480
    v_add_u32 v17, s41, v249
    v_lshl_add_u32 v6, v245, 8, v246
    v_xor_b32 v7, 32, v6
    v_xor_b32 v8, 64, v6
    v_xor_b32 v9, 96, v6
    v_xor_b32 v10, 128, v6
    v_xor_b32 v11, 160, v6
    v_xor_b32 v12, 192, v6
    v_xor_b32 v13, 224, v6
    s_mov_b32 s45, 0x3fb8aa3b
    s_mov_b32 s58, 0x3db504f3
    s_mov_b32 s59, s58
    v_mov_b32 v18, 0xff800000
    v_mov_b32 v252, 0
    s_lshl_b32 s42, s38, 2
    s_add_u32 s42, s42, s36
    s_lshl_b32 s50, s42, 7
    s_lshl_b32 s48, s38, 11
    s_lshl_b32 s41, s39, 8
    s_add_u32 s49, s48, s41
    s_add_u32 s49, s49, 0x10000
    s_lshl_b32 s41, s39, 5
    s_add_u32 s48, s48, s41
    s_add_u32 s48, s48, 0x10000
    s_lshl_b32 s46, s42, 14
    s_lshl_b32 s41, s39, 8
    s_add_u32 s47, s46, s41
    s_add_u32 s47, s47, 0x80000
    s_lshl_b32 s41, s39, 11
    s_add_u32 s46, s46, s41
    s_add_u32 s46, s46, 0x80000
    s_lshl_b32 s52, s36, 6
    s_lshl_b32 s55, 1, s39
    s_movk_i32 s54, 0xff
    s_mov_b32 s43, 0x200000
    v_lshlrev_b32 v2, 3, v0
    v_bfe_u32 v248, v0, 2, 3
    v_lshlrev_b32 v1, 11, v248
    v_lshl_add_u32 v1, v244, 6, v1
    v_lshl_add_u32 v1, v250, 4, v1
    v_lshlrev_b32 v3, 4, v0
    v_lshrrev_b32 v4, 4, v0
    v_lshlrev_b32 v4, 8, v4
    v_lshl_add_u32 v4, v250, 3, v4
    v_lshlrev_b32 v5, 8, v250
    v_bfe_u32 v248, v0, 3, 1
    v_lshl_add_u32 v5, v248, 5, v5
    v_lshl_add_u32 v5, v244, 4, v5
    v_bfe_u32 v248, v0, 2, 1
    v_lshl_add_u32 v5, v248, 3, v5
    v_bfe_u32 v248, v0, 4, 1
    v_lshl_add_u32 v5, v248, 2, v5
    v_mov_b32 v253, s55
    v_mov_b32 v254, s55
    s_lshl_b32 s41, s38, 13
    s_lshl_b32 s44, s39, 10
    s_add_u32 s41, s41, s44
    s_add_u32 s24, s10, s41
    s_addc_u32 s25, s11, 0
    s_mov_b32 s26, 0x400
    s_waitcnt vmcnt(0)
    s_barrier
    ds_read_b128 v[20:23], v6
    ds_read_b128 v[24:27], v7
    ds_read_b128 v[28:31], v8
    ds_read_b128 v[32:35], v9
    ds_read_b128 v[36:39], v10
    ds_read_b128 v[40:43], v11
    ds_read_b128 v[44:47], v12
    ds_read_b128 v[48:51], v13
    v_add_u32 v6, s37, v6
    v_add_u32 v7, s37, v7
    v_add_u32 v8, s37, v8
    v_add_u32 v9, s37, v9
    v_add_u32 v10, s37, v10
    v_add_u32 v11, s37, v11
    v_add_u32 v12, s37, v12
    v_add_u32 v13, s37, v13
    ds_read_b128 v[52:55], v6 offset:0
    ds_read_b128 v[56:59], v7 offset:0
    ds_read_b128 v[60:63], v8 offset:0
    ds_read_b128 v[64:67], v9 offset:0
    ds_read_b128 v[68:71], v10 offset:0
    ds_read_b128 v[72:75], v11 offset:0
    ds_read_b128 v[76:79], v12 offset:0
    ds_read_b128 v[80:83], v13 offset:0
    s_waitcnt lgkmcnt(7)
    v_mfma_f32_32x32x16_bf16 v[84:99], v[52:55], v[20:23], 0
    s_waitcnt lgkmcnt(6)
    v_mfma_f32_32x32x16_bf16 v[84:99], v[56:59], v[24:27], v[84:99]
    s_waitcnt lgkmcnt(5)
    v_mfma_f32_32x32x16_bf16 v[84:99], v[60:63], v[28:31], v[84:99]
    s_waitcnt lgkmcnt(4)
    v_mfma_f32_32x32x16_bf16 v[84:99], v[64:67], v[32:35], v[84:99]
    s_waitcnt lgkmcnt(3)
    v_mfma_f32_32x32x16_bf16 v[84:99], v[68:71], v[36:39], v[84:99]
    s_waitcnt lgkmcnt(2)
    v_mfma_f32_32x32x16_bf16 v[84:99], v[72:75], v[40:43], v[84:99]
    s_waitcnt lgkmcnt(1)
    v_mfma_f32_32x32x16_bf16 v[84:99], v[76:79], v[44:47], v[84:99]
    s_waitcnt lgkmcnt(0)
    v_mfma_f32_32x32x16_bf16 v[84:99], v[80:83], v[48:51], v[84:99]
    s_barrier
    ds_read_b128 v[52:55], v6 offset:8192
    ds_read_b128 v[56:59], v7 offset:8192
    ds_read_b128 v[60:63], v8 offset:8192
    ds_read_b128 v[64:67], v9 offset:8192
    ds_read_b128 v[68:71], v10 offset:8192
    ds_read_b128 v[72:75], v11 offset:8192
    ds_read_b128 v[76:79], v12 offset:8192
    ds_read_b128 v[80:83], v13 offset:8192
    s_nop 3
    v_max3_f32 v18, v84, v85, v18
    v_max3_f32 v18, v86, v87, v18
    v_max3_f32 v18, v88, v89, v18
    v_max3_f32 v18, v90, v91, v18
    v_max3_f32 v18, v92, v93, v18
    v_max3_f32 v18, v94, v95, v18
    v_max3_f32 v18, v96, v97, v18
    v_max3_f32 v18, v98, v99, v18
    s_waitcnt lgkmcnt(7)
    v_mfma_f32_32x32x16_bf16 v[100:115], v[52:55], v[20:23], 0
    s_waitcnt lgkmcnt(6)
    v_mfma_f32_32x32x16_bf16 v[100:115], v[56:59], v[24:27], v[100:115]
    s_waitcnt lgkmcnt(5)
    v_mfma_f32_32x32x16_bf16 v[100:115], v[60:63], v[28:31], v[100:115]
    s_waitcnt lgkmcnt(4)
    v_mfma_f32_32x32x16_bf16 v[100:115], v[64:67], v[32:35], v[100:115]
    s_waitcnt lgkmcnt(3)
    v_mfma_f32_32x32x16_bf16 v[100:115], v[68:71], v[36:39], v[100:115]
    s_waitcnt lgkmcnt(2)
    v_mfma_f32_32x32x16_bf16 v[100:115], v[72:75], v[40:43], v[100:115]
    s_waitcnt lgkmcnt(1)
    v_mfma_f32_32x32x16_bf16 v[100:115], v[76:79], v[44:47], v[100:115]
    s_waitcnt lgkmcnt(0)
    v_mfma_f32_32x32x16_bf16 v[100:115], v[80:83], v[48:51], v[100:115]
    v_cvt_pk_bf16_f32 v84, v84, v85
    v_cvt_pk_bf16_f32 v86, v86, v87
    v_cvt_pk_bf16_f32 v88, v88, v89
    v_cvt_pk_bf16_f32 v90, v90, v91
    v_cvt_pk_bf16_f32 v92, v92, v93
    v_cvt_pk_bf16_f32 v94, v94, v95
    v_cvt_pk_bf16_f32 v96, v96, v97
    v_cvt_pk_bf16_f32 v98, v98, v99
    v_and_b32 v85, 0xffff0000, v84
    v_lshlrev_b32 v84, 16, v84
    v_and_b32 v87, 0xffff0000, v86
    v_lshlrev_b32 v86, 16, v86
    v_and_b32 v89, 0xffff0000, v88
    v_lshlrev_b32 v88, 16, v88
    v_and_b32 v91, 0xffff0000, v90
    v_lshlrev_b32 v90, 16, v90
    v_and_b32 v93, 0xffff0000, v92
    v_lshlrev_b32 v92, 16, v92
    v_and_b32 v95, 0xffff0000, v94
    v_lshlrev_b32 v94, 16, v94
    v_and_b32 v97, 0xffff0000, v96
    v_lshlrev_b32 v96, 16, v96
    v_and_b32 v99, 0xffff0000, v98
    v_lshlrev_b32 v98, 16, v98
    v_pk_mul_f32 v[84:85], v[84:85], s[58:59]
    v_pk_mul_f32 v[86:87], v[86:87], s[58:59]
    v_pk_mul_f32 v[88:89], v[88:89], s[58:59]
    v_pk_mul_f32 v[90:91], v[90:91], s[58:59]
    v_pk_mul_f32 v[92:93], v[92:93], s[58:59]
    v_pk_mul_f32 v[94:95], v[94:95], s[58:59]
    v_pk_mul_f32 v[96:97], v[96:97], s[58:59]
    v_pk_mul_f32 v[98:99], v[98:99], s[58:59]
    v_cvt_pk_bf16_f32 v84, v84, v85
    v_cvt_pk_bf16_f32 v86, v86, v87
    v_cvt_pk_bf16_f32 v88, v88, v89
    v_cvt_pk_bf16_f32 v90, v90, v91
    v_cvt_pk_bf16_f32 v92, v92, v93
    v_cvt_pk_bf16_f32 v94, v94, v95
    v_cvt_pk_bf16_f32 v96, v96, v97
    v_cvt_pk_bf16_f32 v98, v98, v99
    v_and_b32 v85, 0xffff0000, v84
    v_lshlrev_b32 v84, 16, v84
    v_and_b32 v87, 0xffff0000, v86
    v_lshlrev_b32 v86, 16, v86
    v_and_b32 v89, 0xffff0000, v88
    v_lshlrev_b32 v88, 16, v88
    v_and_b32 v91, 0xffff0000, v90
    v_lshlrev_b32 v90, 16, v90
    v_and_b32 v93, 0xffff0000, v92
    v_lshlrev_b32 v92, 16, v92
    v_and_b32 v95, 0xffff0000, v94
    v_lshlrev_b32 v94, 16, v94
    v_and_b32 v97, 0xffff0000, v96
    v_lshlrev_b32 v96, 16, v96
    v_and_b32 v99, 0xffff0000, v98
    v_lshlrev_b32 v98, 16, v98
    s_barrier
    ds_read_b128 v[52:55], v6 offset:16384
    ds_read_b128 v[56:59], v7 offset:16384
    ds_read_b128 v[60:63], v8 offset:16384
    ds_read_b128 v[64:67], v9 offset:16384
    ds_read_b128 v[68:71], v10 offset:16384
    ds_read_b128 v[72:75], v11 offset:16384
    ds_read_b128 v[76:79], v12 offset:16384
    ds_read_b128 v[80:83], v13 offset:16384
    s_nop 3
    v_max3_f32 v18, v100, v101, v18
    v_max3_f32 v18, v102, v103, v18
    v_max3_f32 v18, v104, v105, v18
    v_max3_f32 v18, v106, v107, v18
    v_max3_f32 v18, v108, v109, v18
    v_max3_f32 v18, v110, v111, v18
    v_max3_f32 v18, v112, v113, v18
    v_max3_f32 v18, v114, v115, v18
    s_waitcnt lgkmcnt(7)
    v_mfma_f32_32x32x16_bf16 v[116:131], v[52:55], v[20:23], 0
    s_waitcnt lgkmcnt(6)
    v_mfma_f32_32x32x16_bf16 v[116:131], v[56:59], v[24:27], v[116:131]
    s_waitcnt lgkmcnt(5)
    v_mfma_f32_32x32x16_bf16 v[116:131], v[60:63], v[28:31], v[116:131]
    s_waitcnt lgkmcnt(4)
    v_mfma_f32_32x32x16_bf16 v[116:131], v[64:67], v[32:35], v[116:131]
    s_waitcnt lgkmcnt(3)
    v_mfma_f32_32x32x16_bf16 v[116:131], v[68:71], v[36:39], v[116:131]
    s_waitcnt lgkmcnt(2)
    v_mfma_f32_32x32x16_bf16 v[116:131], v[72:75], v[40:43], v[116:131]
    s_waitcnt lgkmcnt(1)
    v_mfma_f32_32x32x16_bf16 v[116:131], v[76:79], v[44:47], v[116:131]
    s_waitcnt lgkmcnt(0)
    v_mfma_f32_32x32x16_bf16 v[116:131], v[80:83], v[48:51], v[116:131]
    v_cvt_pk_bf16_f32 v100, v100, v101
    v_cvt_pk_bf16_f32 v102, v102, v103
    v_cvt_pk_bf16_f32 v104, v104, v105
    v_cvt_pk_bf16_f32 v106, v106, v107
    v_cvt_pk_bf16_f32 v108, v108, v109
    v_cvt_pk_bf16_f32 v110, v110, v111
    v_cvt_pk_bf16_f32 v112, v112, v113
    v_cvt_pk_bf16_f32 v114, v114, v115
    v_and_b32 v101, 0xffff0000, v100
    v_lshlrev_b32 v100, 16, v100
    v_and_b32 v103, 0xffff0000, v102
    v_lshlrev_b32 v102, 16, v102
    v_and_b32 v105, 0xffff0000, v104
    v_lshlrev_b32 v104, 16, v104
    v_and_b32 v107, 0xffff0000, v106
    v_lshlrev_b32 v106, 16, v106
    v_and_b32 v109, 0xffff0000, v108
    v_lshlrev_b32 v108, 16, v108
    v_and_b32 v111, 0xffff0000, v110
    v_lshlrev_b32 v110, 16, v110
    v_and_b32 v113, 0xffff0000, v112
    v_lshlrev_b32 v112, 16, v112
    v_and_b32 v115, 0xffff0000, v114
    v_lshlrev_b32 v114, 16, v114
    v_pk_mul_f32 v[100:101], v[100:101], s[58:59]
    v_pk_mul_f32 v[102:103], v[102:103], s[58:59]
    v_pk_mul_f32 v[104:105], v[104:105], s[58:59]
    v_pk_mul_f32 v[106:107], v[106:107], s[58:59]
    v_pk_mul_f32 v[108:109], v[108:109], s[58:59]
    v_pk_mul_f32 v[110:111], v[110:111], s[58:59]
    v_pk_mul_f32 v[112:113], v[112:113], s[58:59]
    v_pk_mul_f32 v[114:115], v[114:115], s[58:59]
    v_cvt_pk_bf16_f32 v100, v100, v101
    v_cvt_pk_bf16_f32 v102, v102, v103
    v_cvt_pk_bf16_f32 v104, v104, v105
    v_cvt_pk_bf16_f32 v106, v106, v107
    v_cvt_pk_bf16_f32 v108, v108, v109
    v_cvt_pk_bf16_f32 v110, v110, v111
    v_cvt_pk_bf16_f32 v112, v112, v113
    v_cvt_pk_bf16_f32 v114, v114, v115
    v_and_b32 v101, 0xffff0000, v100
    v_lshlrev_b32 v100, 16, v100
    v_and_b32 v103, 0xffff0000, v102
    v_lshlrev_b32 v102, 16, v102
    v_and_b32 v105, 0xffff0000, v104
    v_lshlrev_b32 v104, 16, v104
    v_and_b32 v107, 0xffff0000, v106
    v_lshlrev_b32 v106, 16, v106
    v_and_b32 v109, 0xffff0000, v108
    v_lshlrev_b32 v108, 16, v108
    v_and_b32 v111, 0xffff0000, v110
    v_lshlrev_b32 v110, 16, v110
    v_and_b32 v113, 0xffff0000, v112
    v_lshlrev_b32 v112, 16, v112
    v_and_b32 v115, 0xffff0000, v114
    v_lshlrev_b32 v114, 16, v114
    s_barrier
    ds_read_b128 v[52:55], v6 offset:24576
    ds_read_b128 v[56:59], v7 offset:24576
    ds_read_b128 v[60:63], v8 offset:24576
    ds_read_b128 v[64:67], v9 offset:24576
    ds_read_b128 v[68:71], v10 offset:24576
    ds_read_b128 v[72:75], v11 offset:24576
    ds_read_b128 v[76:79], v12 offset:24576
    ds_read_b128 v[80:83], v13 offset:24576
    s_nop 3
    v_max3_f32 v18, v116, v117, v18
    v_max3_f32 v18, v118, v119, v18
    v_max3_f32 v18, v120, v121, v18
    v_max3_f32 v18, v122, v123, v18
    v_max3_f32 v18, v124, v125, v18
    v_max3_f32 v18, v126, v127, v18
    v_max3_f32 v18, v128, v129, v18
    v_max3_f32 v18, v130, v131, v18
    s_waitcnt lgkmcnt(7)
    v_mfma_f32_32x32x16_bf16 v[132:147], v[52:55], v[20:23], 0
    s_waitcnt lgkmcnt(6)
    v_mfma_f32_32x32x16_bf16 v[132:147], v[56:59], v[24:27], v[132:147]
    s_waitcnt lgkmcnt(5)
    v_mfma_f32_32x32x16_bf16 v[132:147], v[60:63], v[28:31], v[132:147]
    s_waitcnt lgkmcnt(4)
    v_mfma_f32_32x32x16_bf16 v[132:147], v[64:67], v[32:35], v[132:147]
    s_waitcnt lgkmcnt(3)
    v_mfma_f32_32x32x16_bf16 v[132:147], v[68:71], v[36:39], v[132:147]
    s_waitcnt lgkmcnt(2)
    v_mfma_f32_32x32x16_bf16 v[132:147], v[72:75], v[40:43], v[132:147]
    s_waitcnt lgkmcnt(1)
    v_mfma_f32_32x32x16_bf16 v[132:147], v[76:79], v[44:47], v[132:147]
    s_waitcnt lgkmcnt(0)
    v_mfma_f32_32x32x16_bf16 v[132:147], v[80:83], v[48:51], v[132:147]
    v_cvt_pk_bf16_f32 v116, v116, v117
    v_cvt_pk_bf16_f32 v118, v118, v119
    v_cvt_pk_bf16_f32 v120, v120, v121
    v_cvt_pk_bf16_f32 v122, v122, v123
    v_cvt_pk_bf16_f32 v124, v124, v125
    v_cvt_pk_bf16_f32 v126, v126, v127
    v_cvt_pk_bf16_f32 v128, v128, v129
    v_cvt_pk_bf16_f32 v130, v130, v131
    v_and_b32 v117, 0xffff0000, v116
    v_lshlrev_b32 v116, 16, v116
    v_and_b32 v119, 0xffff0000, v118
    v_lshlrev_b32 v118, 16, v118
    v_and_b32 v121, 0xffff0000, v120
    v_lshlrev_b32 v120, 16, v120
    v_and_b32 v123, 0xffff0000, v122
    v_lshlrev_b32 v122, 16, v122
    v_and_b32 v125, 0xffff0000, v124
    v_lshlrev_b32 v124, 16, v124
    v_and_b32 v127, 0xffff0000, v126
    v_lshlrev_b32 v126, 16, v126
    v_and_b32 v129, 0xffff0000, v128
    v_lshlrev_b32 v128, 16, v128
    v_and_b32 v131, 0xffff0000, v130
    v_lshlrev_b32 v130, 16, v130
    v_pk_mul_f32 v[116:117], v[116:117], s[58:59]
    v_pk_mul_f32 v[118:119], v[118:119], s[58:59]
    v_pk_mul_f32 v[120:121], v[120:121], s[58:59]
    v_pk_mul_f32 v[122:123], v[122:123], s[58:59]
    v_pk_mul_f32 v[124:125], v[124:125], s[58:59]
    v_pk_mul_f32 v[126:127], v[126:127], s[58:59]
    v_pk_mul_f32 v[128:129], v[128:129], s[58:59]
    v_pk_mul_f32 v[130:131], v[130:131], s[58:59]
    v_cvt_pk_bf16_f32 v116, v116, v117
    v_cvt_pk_bf16_f32 v118, v118, v119
    v_cvt_pk_bf16_f32 v120, v120, v121
    v_cvt_pk_bf16_f32 v122, v122, v123
    v_cvt_pk_bf16_f32 v124, v124, v125
    v_cvt_pk_bf16_f32 v126, v126, v127
    v_cvt_pk_bf16_f32 v128, v128, v129
    v_cvt_pk_bf16_f32 v130, v130, v131
    v_and_b32 v117, 0xffff0000, v116
    v_lshlrev_b32 v116, 16, v116
    v_and_b32 v119, 0xffff0000, v118
    v_lshlrev_b32 v118, 16, v118
    v_and_b32 v121, 0xffff0000, v120
    v_lshlrev_b32 v120, 16, v120
    v_and_b32 v123, 0xffff0000, v122
    v_lshlrev_b32 v122, 16, v122
    v_and_b32 v125, 0xffff0000, v124
    v_lshlrev_b32 v124, 16, v124
    v_and_b32 v127, 0xffff0000, v126
    v_lshlrev_b32 v126, 16, v126
    v_and_b32 v129, 0xffff0000, v128
    v_lshlrev_b32 v128, 16, v128
    v_and_b32 v131, 0xffff0000, v130
    v_lshlrev_b32 v130, 16, v130
    s_barrier
    ds_read_b128 v[52:55], v6 offset:0
    ds_read_b128 v[56:59], v7 offset:0
    ds_read_b128 v[60:63], v8 offset:0
    ds_read_b128 v[64:67], v9 offset:0
    ds_read_b128 v[68:71], v10 offset:0
    ds_read_b128 v[72:75], v11 offset:0
    ds_read_b128 v[76:79], v12 offset:0
    ds_read_b128 v[80:83], v13 offset:0
    s_nop 3
    v_max3_f32 v18, v132, v133, v18
    v_max3_f32 v18, v134, v135, v18
    v_max3_f32 v18, v136, v137, v18
    v_max3_f32 v18, v138, v139, v18
    v_max3_f32 v18, v140, v141, v18
    v_max3_f32 v18, v142, v143, v18
    v_max3_f32 v18, v144, v145, v18
    v_max3_f32 v18, v146, v147, v18
    s_waitcnt lgkmcnt(7)
    v_mfma_f32_32x32x16_bf16 v[148:163], v[52:55], v[20:23], 0
    s_waitcnt lgkmcnt(6)
    v_mfma_f32_32x32x16_bf16 v[148:163], v[56:59], v[24:27], v[148:163]
    s_waitcnt lgkmcnt(5)
    v_mfma_f32_32x32x16_bf16 v[148:163], v[60:63], v[28:31], v[148:163]
    s_waitcnt lgkmcnt(4)
    v_mfma_f32_32x32x16_bf16 v[148:163], v[64:67], v[32:35], v[148:163]
    s_waitcnt lgkmcnt(3)
    v_mfma_f32_32x32x16_bf16 v[148:163], v[68:71], v[36:39], v[148:163]
    s_waitcnt lgkmcnt(2)
    v_mfma_f32_32x32x16_bf16 v[148:163], v[72:75], v[40:43], v[148:163]
    s_waitcnt lgkmcnt(1)
    v_mfma_f32_32x32x16_bf16 v[148:163], v[76:79], v[44:47], v[148:163]
    s_waitcnt lgkmcnt(0)
    v_mfma_f32_32x32x16_bf16 v[148:163], v[80:83], v[48:51], v[148:163]
    v_cvt_pk_bf16_f32 v132, v132, v133
    v_cvt_pk_bf16_f32 v134, v134, v135
    v_cvt_pk_bf16_f32 v136, v136, v137
    v_cvt_pk_bf16_f32 v138, v138, v139
    v_cvt_pk_bf16_f32 v140, v140, v141
    v_cvt_pk_bf16_f32 v142, v142, v143
    v_cvt_pk_bf16_f32 v144, v144, v145
    v_cvt_pk_bf16_f32 v146, v146, v147
    v_and_b32 v133, 0xffff0000, v132
    v_lshlrev_b32 v132, 16, v132
    v_and_b32 v135, 0xffff0000, v134
    v_lshlrev_b32 v134, 16, v134
    v_and_b32 v137, 0xffff0000, v136
    v_lshlrev_b32 v136, 16, v136
    v_and_b32 v139, 0xffff0000, v138
    v_lshlrev_b32 v138, 16, v138
    v_and_b32 v141, 0xffff0000, v140
    v_lshlrev_b32 v140, 16, v140
    v_and_b32 v143, 0xffff0000, v142
    v_lshlrev_b32 v142, 16, v142
    v_and_b32 v145, 0xffff0000, v144
    v_lshlrev_b32 v144, 16, v144
    v_and_b32 v147, 0xffff0000, v146
    v_lshlrev_b32 v146, 16, v146
    v_pk_mul_f32 v[132:133], v[132:133], s[58:59]
    v_pk_mul_f32 v[134:135], v[134:135], s[58:59]
    v_pk_mul_f32 v[136:137], v[136:137], s[58:59]
    v_pk_mul_f32 v[138:139], v[138:139], s[58:59]
    v_pk_mul_f32 v[140:141], v[140:141], s[58:59]
    v_pk_mul_f32 v[142:143], v[142:143], s[58:59]
    v_pk_mul_f32 v[144:145], v[144:145], s[58:59]
    v_pk_mul_f32 v[146:147], v[146:147], s[58:59]
    v_cvt_pk_bf16_f32 v132, v132, v133
    v_cvt_pk_bf16_f32 v134, v134, v135
    v_cvt_pk_bf16_f32 v136, v136, v137
    v_cvt_pk_bf16_f32 v138, v138, v139
    v_cvt_pk_bf16_f32 v140, v140, v141
    v_cvt_pk_bf16_f32 v142, v142, v143
    v_cvt_pk_bf16_f32 v144, v144, v145
    v_cvt_pk_bf16_f32 v146, v146, v147
    v_and_b32 v133, 0xffff0000, v132
    v_lshlrev_b32 v132, 16, v132
    v_and_b32 v135, 0xffff0000, v134
    v_lshlrev_b32 v134, 16, v134
    v_and_b32 v137, 0xffff0000, v136
    v_lshlrev_b32 v136, 16, v136
    v_and_b32 v139, 0xffff0000, v138
    v_lshlrev_b32 v138, 16, v138
    v_and_b32 v141, 0xffff0000, v140
    v_lshlrev_b32 v140, 16, v140
    v_and_b32 v143, 0xffff0000, v142
    v_lshlrev_b32 v142, 16, v142
    v_and_b32 v145, 0xffff0000, v144
    v_lshlrev_b32 v144, 16, v144
    v_and_b32 v147, 0xffff0000, v146
    v_lshlrev_b32 v146, 16, v146
    s_barrier
    ds_read_b128 v[52:55], v6 offset:8192
    ds_read_b128 v[56:59], v7 offset:8192
    ds_read_b128 v[60:63], v8 offset:8192
    ds_read_b128 v[64:67], v9 offset:8192
    ds_read_b128 v[68:71], v10 offset:8192
    ds_read_b128 v[72:75], v11 offset:8192
    ds_read_b128 v[76:79], v12 offset:8192
    ds_read_b128 v[80:83], v13 offset:8192
    s_nop 3
    v_max3_f32 v18, v148, v149, v18
    v_max3_f32 v18, v150, v151, v18
    v_max3_f32 v18, v152, v153, v18
    v_max3_f32 v18, v154, v155, v18
    v_max3_f32 v18, v156, v157, v18
    v_max3_f32 v18, v158, v159, v18
    v_max3_f32 v18, v160, v161, v18
    v_max3_f32 v18, v162, v163, v18
    s_waitcnt lgkmcnt(7)
    v_mfma_f32_32x32x16_bf16 v[164:179], v[52:55], v[20:23], 0
    s_waitcnt lgkmcnt(6)
    v_mfma_f32_32x32x16_bf16 v[164:179], v[56:59], v[24:27], v[164:179]
    s_waitcnt lgkmcnt(5)
    v_mfma_f32_32x32x16_bf16 v[164:179], v[60:63], v[28:31], v[164:179]
    s_waitcnt lgkmcnt(4)
    v_mfma_f32_32x32x16_bf16 v[164:179], v[64:67], v[32:35], v[164:179]
    s_waitcnt lgkmcnt(3)
    v_mfma_f32_32x32x16_bf16 v[164:179], v[68:71], v[36:39], v[164:179]
    s_waitcnt lgkmcnt(2)
    v_mfma_f32_32x32x16_bf16 v[164:179], v[72:75], v[40:43], v[164:179]
    s_waitcnt lgkmcnt(1)
    v_mfma_f32_32x32x16_bf16 v[164:179], v[76:79], v[44:47], v[164:179]
    s_waitcnt lgkmcnt(0)
    v_mfma_f32_32x32x16_bf16 v[164:179], v[80:83], v[48:51], v[164:179]
    v_cvt_pk_bf16_f32 v148, v148, v149
    v_cvt_pk_bf16_f32 v150, v150, v151
    v_cvt_pk_bf16_f32 v152, v152, v153
    v_cvt_pk_bf16_f32 v154, v154, v155
    v_cvt_pk_bf16_f32 v156, v156, v157
    v_cvt_pk_bf16_f32 v158, v158, v159
    v_cvt_pk_bf16_f32 v160, v160, v161
    v_cvt_pk_bf16_f32 v162, v162, v163
    v_and_b32 v149, 0xffff0000, v148
    v_lshlrev_b32 v148, 16, v148
    v_and_b32 v151, 0xffff0000, v150
    v_lshlrev_b32 v150, 16, v150
    v_and_b32 v153, 0xffff0000, v152
    v_lshlrev_b32 v152, 16, v152
    v_and_b32 v155, 0xffff0000, v154
    v_lshlrev_b32 v154, 16, v154
    v_and_b32 v157, 0xffff0000, v156
    v_lshlrev_b32 v156, 16, v156
    v_and_b32 v159, 0xffff0000, v158
    v_lshlrev_b32 v158, 16, v158
    v_and_b32 v161, 0xffff0000, v160
    v_lshlrev_b32 v160, 16, v160
    v_and_b32 v163, 0xffff0000, v162
    v_lshlrev_b32 v162, 16, v162
    v_pk_mul_f32 v[148:149], v[148:149], s[58:59]
    v_pk_mul_f32 v[150:151], v[150:151], s[58:59]
    v_pk_mul_f32 v[152:153], v[152:153], s[58:59]
    v_pk_mul_f32 v[154:155], v[154:155], s[58:59]
    v_pk_mul_f32 v[156:157], v[156:157], s[58:59]
    v_pk_mul_f32 v[158:159], v[158:159], s[58:59]
    v_pk_mul_f32 v[160:161], v[160:161], s[58:59]
    v_pk_mul_f32 v[162:163], v[162:163], s[58:59]
    v_cvt_pk_bf16_f32 v148, v148, v149
    v_cvt_pk_bf16_f32 v150, v150, v151
    v_cvt_pk_bf16_f32 v152, v152, v153
    v_cvt_pk_bf16_f32 v154, v154, v155
    v_cvt_pk_bf16_f32 v156, v156, v157
    v_cvt_pk_bf16_f32 v158, v158, v159
    v_cvt_pk_bf16_f32 v160, v160, v161
    v_cvt_pk_bf16_f32 v162, v162, v163
    v_and_b32 v149, 0xffff0000, v148
    v_lshlrev_b32 v148, 16, v148
    v_and_b32 v151, 0xffff0000, v150
    v_lshlrev_b32 v150, 16, v150
    v_and_b32 v153, 0xffff0000, v152
    v_lshlrev_b32 v152, 16, v152
    v_and_b32 v155, 0xffff0000, v154
    v_lshlrev_b32 v154, 16, v154
    v_and_b32 v157, 0xffff0000, v156
    v_lshlrev_b32 v156, 16, v156
    v_and_b32 v159, 0xffff0000, v158
    v_lshlrev_b32 v158, 16, v158
    v_and_b32 v161, 0xffff0000, v160
    v_lshlrev_b32 v160, 16, v160
    v_and_b32 v163, 0xffff0000, v162
    v_lshlrev_b32 v162, 16, v162
    s_barrier
    ds_read_b128 v[52:55], v6 offset:16384
    ds_read_b128 v[56:59], v7 offset:16384
    ds_read_b128 v[60:63], v8 offset:16384
    ds_read_b128 v[64:67], v9 offset:16384
    ds_read_b128 v[68:71], v10 offset:16384
    ds_read_b128 v[72:75], v11 offset:16384
    ds_read_b128 v[76:79], v12 offset:16384
    ds_read_b128 v[80:83], v13 offset:16384
    s_nop 3
    v_max3_f32 v18, v164, v165, v18
    v_max3_f32 v18, v166, v167, v18
    v_max3_f32 v18, v168, v169, v18
    v_max3_f32 v18, v170, v171, v18
    v_max3_f32 v18, v172, v173, v18
    v_max3_f32 v18, v174, v175, v18
    v_max3_f32 v18, v176, v177, v18
    v_max3_f32 v18, v178, v179, v18
    s_waitcnt lgkmcnt(7)
    v_mfma_f32_32x32x16_bf16 v[180:195], v[52:55], v[20:23], 0
    s_waitcnt lgkmcnt(6)
    v_mfma_f32_32x32x16_bf16 v[180:195], v[56:59], v[24:27], v[180:195]
    s_waitcnt lgkmcnt(5)
    v_mfma_f32_32x32x16_bf16 v[180:195], v[60:63], v[28:31], v[180:195]
    s_waitcnt lgkmcnt(4)
    v_mfma_f32_32x32x16_bf16 v[180:195], v[64:67], v[32:35], v[180:195]
    s_waitcnt lgkmcnt(3)
    v_mfma_f32_32x32x16_bf16 v[180:195], v[68:71], v[36:39], v[180:195]
    s_waitcnt lgkmcnt(2)
    v_mfma_f32_32x32x16_bf16 v[180:195], v[72:75], v[40:43], v[180:195]
    s_waitcnt lgkmcnt(1)
    v_mfma_f32_32x32x16_bf16 v[180:195], v[76:79], v[44:47], v[180:195]
    s_waitcnt lgkmcnt(0)
    v_mfma_f32_32x32x16_bf16 v[180:195], v[80:83], v[48:51], v[180:195]
    v_cvt_pk_bf16_f32 v164, v164, v165
    v_cvt_pk_bf16_f32 v166, v166, v167
    v_cvt_pk_bf16_f32 v168, v168, v169
    v_cvt_pk_bf16_f32 v170, v170, v171
    v_cvt_pk_bf16_f32 v172, v172, v173
    v_cvt_pk_bf16_f32 v174, v174, v175
    v_cvt_pk_bf16_f32 v176, v176, v177
    v_cvt_pk_bf16_f32 v178, v178, v179
    v_and_b32 v165, 0xffff0000, v164
    v_lshlrev_b32 v164, 16, v164
    v_and_b32 v167, 0xffff0000, v166
    v_lshlrev_b32 v166, 16, v166
    v_and_b32 v169, 0xffff0000, v168
    v_lshlrev_b32 v168, 16, v168
    v_and_b32 v171, 0xffff0000, v170
    v_lshlrev_b32 v170, 16, v170
    v_and_b32 v173, 0xffff0000, v172
    v_lshlrev_b32 v172, 16, v172
    v_and_b32 v175, 0xffff0000, v174
    v_lshlrev_b32 v174, 16, v174
    v_and_b32 v177, 0xffff0000, v176
    v_lshlrev_b32 v176, 16, v176
    v_and_b32 v179, 0xffff0000, v178
    v_lshlrev_b32 v178, 16, v178
    v_pk_mul_f32 v[164:165], v[164:165], s[58:59]
    v_pk_mul_f32 v[166:167], v[166:167], s[58:59]
    v_pk_mul_f32 v[168:169], v[168:169], s[58:59]
    v_pk_mul_f32 v[170:171], v[170:171], s[58:59]
    v_pk_mul_f32 v[172:173], v[172:173], s[58:59]
    v_pk_mul_f32 v[174:175], v[174:175], s[58:59]
    v_pk_mul_f32 v[176:177], v[176:177], s[58:59]
    v_pk_mul_f32 v[178:179], v[178:179], s[58:59]
    v_cvt_pk_bf16_f32 v164, v164, v165
    v_cvt_pk_bf16_f32 v166, v166, v167
    v_cvt_pk_bf16_f32 v168, v168, v169
    v_cvt_pk_bf16_f32 v170, v170, v171
    v_cvt_pk_bf16_f32 v172, v172, v173
    v_cvt_pk_bf16_f32 v174, v174, v175
    v_cvt_pk_bf16_f32 v176, v176, v177
    v_cvt_pk_bf16_f32 v178, v178, v179
    v_and_b32 v165, 0xffff0000, v164
    v_lshlrev_b32 v164, 16, v164
    v_and_b32 v167, 0xffff0000, v166
    v_lshlrev_b32 v166, 16, v166
    v_and_b32 v169, 0xffff0000, v168
    v_lshlrev_b32 v168, 16, v168
    v_and_b32 v171, 0xffff0000, v170
    v_lshlrev_b32 v170, 16, v170
    v_and_b32 v173, 0xffff0000, v172
    v_lshlrev_b32 v172, 16, v172
    v_and_b32 v175, 0xffff0000, v174
    v_lshlrev_b32 v174, 16, v174
    v_and_b32 v177, 0xffff0000, v176
    v_lshlrev_b32 v176, 16, v176
    v_and_b32 v179, 0xffff0000, v178
    v_lshlrev_b32 v178, 16, v178
    s_barrier
    ds_read_b128 v[52:55], v6 offset:24576
    ds_read_b128 v[56:59], v7 offset:24576
    ds_read_b128 v[60:63], v8 offset:24576
    ds_read_b128 v[64:67], v9 offset:24576
    ds_read_b128 v[68:71], v10 offset:24576
    ds_read_b128 v[72:75], v11 offset:24576
    ds_read_b128 v[76:79], v12 offset:24576
    ds_read_b128 v[80:83], v13 offset:24576
    s_nop 3
    v_max3_f32 v18, v180, v181, v18
    v_max3_f32 v18, v182, v183, v18
    v_max3_f32 v18, v184, v185, v18
    v_max3_f32 v18, v186, v187, v18
    v_max3_f32 v18, v188, v189, v18
    v_max3_f32 v18, v190, v191, v18
    v_max3_f32 v18, v192, v193, v18
    v_max3_f32 v18, v194, v195, v18
    s_waitcnt lgkmcnt(7)
    v_mfma_f32_32x32x16_bf16 v[196:211], v[52:55], v[20:23], 0
    s_waitcnt lgkmcnt(6)
    v_mfma_f32_32x32x16_bf16 v[196:211], v[56:59], v[24:27], v[196:211]
    s_waitcnt lgkmcnt(5)
    v_mfma_f32_32x32x16_bf16 v[196:211], v[60:63], v[28:31], v[196:211]
    s_waitcnt lgkmcnt(4)
    v_mfma_f32_32x32x16_bf16 v[196:211], v[64:67], v[32:35], v[196:211]
    s_waitcnt lgkmcnt(3)
    v_mfma_f32_32x32x16_bf16 v[196:211], v[68:71], v[36:39], v[196:211]
    s_waitcnt lgkmcnt(2)
    v_mfma_f32_32x32x16_bf16 v[196:211], v[72:75], v[40:43], v[196:211]
    s_waitcnt lgkmcnt(1)
    v_mfma_f32_32x32x16_bf16 v[196:211], v[76:79], v[44:47], v[196:211]
    s_waitcnt lgkmcnt(0)
    v_mfma_f32_32x32x16_bf16 v[196:211], v[80:83], v[48:51], v[196:211]
    v_lshlrev_b32 v245, 4, v0
    v_lshlrev_b32 v246, 2, v0
    s_lshl_b32 s41, s36, 11
    v_add_u32 v6, s41, v245
    s_lshl_b32 s41, s36, 8
    v_add_u32 v10, s41, v246
    v_xor_b32 v7, 2048, v6
    v_xor_b32 v11, 256, v10
    v_xor_b32 v8, 4096, v6
    v_xor_b32 v12, 512, v10
    v_xor_b32 v9, 6144, v6
    v_xor_b32 v13, 768, v10
    s_nop 1
    v_max3_f32 v18, v196, v197, v18
    v_max3_f32 v18, v198, v199, v18
    v_max3_f32 v18, v200, v201, v18
    v_max3_f32 v18, v202, v203, v18
    v_max3_f32 v18, v204, v205, v18
    v_max3_f32 v18, v206, v207, v18
    v_max3_f32 v18, v208, v209, v18
    v_max3_f32 v18, v210, v211, v18
    v_mov_b32 v244, v18
    s_nop 1
    v_permlane32_swap_b32 v244, v18
    v_max_f32 v18, v244, v18
    ds_write_b32 v10, v18 offset:16384
    s_waitcnt lgkmcnt(0)
    s_barrier
    ds_read_b32 v244, v11 offset:16384
    ds_read_b32 v245, v12 offset:16384
    ds_read_b32 v246, v13 offset:16384
    s_waitcnt lgkmcnt(0)
    v_max3_f32 v244, v244, v245, v246
    v_max_f32 v18, v244, v18
    v_cvt_pk_bf16_f32 v18, v18, v18
    v_lshlrev_b32 v18, 16, v18
    v_mul_f32 v18, s58, v18
    v_cvt_pk_bf16_f32 v18, v18, v18
    v_lshlrev_b32 v18, 16, v18
    v_mul_f32 v18, s45, v18
    v_fma_f32 v84, v84, s45, -v18
    v_fma_f32 v85, v85, s45, -v18
    v_fma_f32 v86, v86, s45, -v18
    v_fma_f32 v87, v87, s45, -v18
    v_fma_f32 v88, v88, s45, -v18
    v_fma_f32 v89, v89, s45, -v18
    v_fma_f32 v90, v90, s45, -v18
    v_fma_f32 v91, v91, s45, -v18
    v_fma_f32 v92, v92, s45, -v18
    v_fma_f32 v93, v93, s45, -v18
    v_fma_f32 v94, v94, s45, -v18
    v_fma_f32 v95, v95, s45, -v18
    v_fma_f32 v96, v96, s45, -v18
    v_fma_f32 v97, v97, s45, -v18
    v_fma_f32 v98, v98, s45, -v18
    v_fma_f32 v99, v99, s45, -v18
    v_exp_f32 v84, v84
    v_exp_f32 v85, v85
    v_exp_f32 v86, v86
    v_exp_f32 v87, v87
    v_exp_f32 v88, v88
    v_exp_f32 v89, v89
    v_exp_f32 v90, v90
    v_exp_f32 v91, v91
    v_exp_f32 v92, v92
    v_exp_f32 v93, v93
    v_exp_f32 v94, v94
    v_exp_f32 v95, v95
    v_exp_f32 v96, v96
    v_exp_f32 v97, v97
    v_exp_f32 v98, v98
    v_exp_f32 v99, v99
    v_add_f32 v19, v84, v85
    v_add_f32 v19, v19, v86
    v_add_f32 v19, v19, v87
    v_add_f32 v19, v19, v88
    v_add_f32 v19, v19, v89
    v_add_f32 v19, v19, v90
    v_add_f32 v19, v19, v91
    v_add_f32 v19, v19, v92
    v_add_f32 v19, v19, v93
    v_add_f32 v19, v19, v94
    v_add_f32 v19, v19, v95
    v_add_f32 v19, v19, v96
    v_add_f32 v19, v19, v97
    v_add_f32 v19, v19, v98
    v_add_f32 v19, v19, v99
    v_cvt_pk_bf16_f32 v84, v84, v85
    v_cvt_pk_bf16_f32 v85, v86, v87
    v_cvt_pk_bf16_f32 v86, v88, v89
    v_cvt_pk_bf16_f32 v87, v90, v91
    v_cvt_pk_bf16_f32 v88, v92, v93
    v_cvt_pk_bf16_f32 v89, v94, v95
    v_cvt_pk_bf16_f32 v90, v96, v97
    v_cvt_pk_bf16_f32 v91, v98, v99
    ds_write_b128 v6, v[84:87] offset:0
    ds_write_b128 v6, v[88:91] offset:1024
    s_waitcnt lgkmcnt(0)
    s_barrier
    ds_read_b128 v[36:39], v7 offset:0
    ds_read_b128 v[40:43], v7 offset:1024
    ds_read_b128 v[44:47], v8 offset:0
    ds_read_b128 v[48:51], v8 offset:1024
    ds_read_b128 v[52:55], v9 offset:0
    ds_read_b128 v[56:59], v9 offset:1024
    v_fma_f32 v100, v100, s45, -v18
    v_fma_f32 v101, v101, s45, -v18
    v_fma_f32 v102, v102, s45, -v18
    v_fma_f32 v103, v103, s45, -v18
    v_fma_f32 v104, v104, s45, -v18
    v_fma_f32 v105, v105, s45, -v18
    v_fma_f32 v106, v106, s45, -v18
    v_fma_f32 v107, v107, s45, -v18
    v_fma_f32 v108, v108, s45, -v18
    v_fma_f32 v109, v109, s45, -v18
    v_fma_f32 v110, v110, s45, -v18
    v_fma_f32 v111, v111, s45, -v18
    v_fma_f32 v112, v112, s45, -v18
    v_fma_f32 v113, v113, s45, -v18
    v_fma_f32 v114, v114, s45, -v18
    v_fma_f32 v115, v115, s45, -v18
    v_exp_f32 v100, v100
    v_exp_f32 v101, v101
    v_exp_f32 v102, v102
    v_exp_f32 v103, v103
    v_exp_f32 v104, v104
    v_exp_f32 v105, v105
    v_exp_f32 v106, v106
    v_exp_f32 v107, v107
    v_exp_f32 v108, v108
    v_exp_f32 v109, v109
    v_exp_f32 v110, v110
    v_exp_f32 v111, v111
    v_exp_f32 v112, v112
    v_exp_f32 v113, v113
    v_exp_f32 v114, v114
    v_exp_f32 v115, v115
    v_add_f32 v19, v19, v100
    v_add_f32 v19, v19, v101
    v_add_f32 v19, v19, v102
    v_add_f32 v19, v19, v103
    v_add_f32 v19, v19, v104
    v_add_f32 v19, v19, v105
    v_add_f32 v19, v19, v106
    v_add_f32 v19, v19, v107
    v_add_f32 v19, v19, v108
    v_add_f32 v19, v19, v109
    v_add_f32 v19, v19, v110
    v_add_f32 v19, v19, v111
    v_add_f32 v19, v19, v112
    v_add_f32 v19, v19, v113
    v_add_f32 v19, v19, v114
    v_add_f32 v19, v19, v115
    v_cvt_pk_bf16_f32 v100, v100, v101
    v_cvt_pk_bf16_f32 v101, v102, v103
    v_cvt_pk_bf16_f32 v102, v104, v105
    v_cvt_pk_bf16_f32 v103, v106, v107
    v_cvt_pk_bf16_f32 v104, v108, v109
    v_cvt_pk_bf16_f32 v105, v110, v111
    v_cvt_pk_bf16_f32 v106, v112, v113
    v_cvt_pk_bf16_f32 v107, v114, v115
    ds_write_b128 v6, v[100:103] offset:8192
    ds_write_b128 v6, v[104:107] offset:9216
    s_waitcnt lgkmcnt(0)
    s_barrier
    ds_read_b64_tr_b16 v[212:213], v14 offset:0
    ds_read_b64_tr_b16 v[214:215], v14 offset:2048
    ds_read_b64_tr_b16 v[216:217], v14 offset:4096
    ds_read_b64_tr_b16 v[218:219], v14 offset:6144
    ds_read_b64_tr_b16 v[220:221], v15 offset:0
    ds_read_b64_tr_b16 v[222:223], v15 offset:2048
    ds_read_b64_tr_b16 v[224:225], v15 offset:4096
    ds_read_b64_tr_b16 v[226:227], v15 offset:6144
    ds_read_b64_tr_b16 v[228:229], v16 offset:0
    ds_read_b64_tr_b16 v[230:231], v16 offset:2048
    ds_read_b64_tr_b16 v[232:233], v16 offset:4096
    ds_read_b64_tr_b16 v[234:235], v16 offset:6144
    ds_read_b64_tr_b16 v[236:237], v17 offset:0
    ds_read_b64_tr_b16 v[238:239], v17 offset:2048
    ds_read_b64_tr_b16 v[240:241], v17 offset:4096
    ds_read_b64_tr_b16 v[242:243], v17 offset:6144
    s_waitcnt lgkmcnt(14)
    v_mfma_f32_32x32x16_bf16 v[20:35], v[212:215], v[84:87], 0
    s_waitcnt lgkmcnt(12)
    v_mfma_f32_32x32x16_bf16 v[20:35], v[216:219], v[88:91], v[20:35]
    s_waitcnt lgkmcnt(10)
    v_mfma_f32_32x32x16_bf16 v[20:35], v[220:223], v[36:39], v[20:35]
    s_waitcnt lgkmcnt(8)
    v_mfma_f32_32x32x16_bf16 v[20:35], v[224:227], v[40:43], v[20:35]
    s_waitcnt lgkmcnt(6)
    v_mfma_f32_32x32x16_bf16 v[20:35], v[228:231], v[44:47], v[20:35]
    s_waitcnt lgkmcnt(4)
    v_mfma_f32_32x32x16_bf16 v[20:35], v[232:235], v[48:51], v[20:35]
    s_waitcnt lgkmcnt(2)
    v_mfma_f32_32x32x16_bf16 v[20:35], v[236:239], v[52:55], v[20:35]
    s_waitcnt lgkmcnt(0)
    v_mfma_f32_32x32x16_bf16 v[20:35], v[240:243], v[56:59], v[20:35]
    ds_read_b128 v[60:63], v7 offset:8192
    ds_read_b128 v[64:67], v7 offset:9216
    ds_read_b128 v[68:71], v8 offset:8192
    ds_read_b128 v[72:75], v8 offset:9216
    ds_read_b128 v[76:79], v9 offset:8192
    ds_read_b128 v[80:83], v9 offset:9216
    v_fma_f32 v116, v116, s45, -v18
    v_fma_f32 v117, v117, s45, -v18
    v_fma_f32 v118, v118, s45, -v18
    v_fma_f32 v119, v119, s45, -v18
    v_fma_f32 v120, v120, s45, -v18
    v_fma_f32 v121, v121, s45, -v18
    v_fma_f32 v122, v122, s45, -v18
    v_fma_f32 v123, v123, s45, -v18
    v_fma_f32 v124, v124, s45, -v18
    v_fma_f32 v125, v125, s45, -v18
    v_fma_f32 v126, v126, s45, -v18
    v_fma_f32 v127, v127, s45, -v18
    v_fma_f32 v128, v128, s45, -v18
    v_fma_f32 v129, v129, s45, -v18
    v_fma_f32 v130, v130, s45, -v18
    v_fma_f32 v131, v131, s45, -v18
    v_exp_f32 v116, v116
    v_exp_f32 v117, v117
    v_exp_f32 v118, v118
    v_exp_f32 v119, v119
    v_exp_f32 v120, v120
    v_exp_f32 v121, v121
    v_exp_f32 v122, v122
    v_exp_f32 v123, v123
    v_exp_f32 v124, v124
    v_exp_f32 v125, v125
    v_exp_f32 v126, v126
    v_exp_f32 v127, v127
    v_exp_f32 v128, v128
    v_exp_f32 v129, v129
    v_exp_f32 v130, v130
    v_exp_f32 v131, v131
    v_add_f32 v19, v19, v116
    v_add_f32 v19, v19, v117
    v_add_f32 v19, v19, v118
    v_add_f32 v19, v19, v119
    v_add_f32 v19, v19, v120
    v_add_f32 v19, v19, v121
    v_add_f32 v19, v19, v122
    v_add_f32 v19, v19, v123
    v_add_f32 v19, v19, v124
    v_add_f32 v19, v19, v125
    v_add_f32 v19, v19, v126
    v_add_f32 v19, v19, v127
    v_add_f32 v19, v19, v128
    v_add_f32 v19, v19, v129
    v_add_f32 v19, v19, v130
    v_add_f32 v19, v19, v131
    v_cvt_pk_bf16_f32 v116, v116, v117
    v_cvt_pk_bf16_f32 v117, v118, v119
    v_cvt_pk_bf16_f32 v118, v120, v121
    v_cvt_pk_bf16_f32 v119, v122, v123
    v_cvt_pk_bf16_f32 v120, v124, v125
    v_cvt_pk_bf16_f32 v121, v126, v127
    v_cvt_pk_bf16_f32 v122, v128, v129
    v_cvt_pk_bf16_f32 v123, v130, v131
    v_fma_f32 v132, v132, s45, -v18
    v_fma_f32 v133, v133, s45, -v18
    v_fma_f32 v134, v134, s45, -v18
    v_fma_f32 v135, v135, s45, -v18
    v_fma_f32 v136, v136, s45, -v18
    v_fma_f32 v137, v137, s45, -v18
    v_fma_f32 v138, v138, s45, -v18
    v_fma_f32 v139, v139, s45, -v18
    v_fma_f32 v140, v140, s45, -v18
    v_fma_f32 v141, v141, s45, -v18
    v_fma_f32 v142, v142, s45, -v18
    v_fma_f32 v143, v143, s45, -v18
    v_fma_f32 v144, v144, s45, -v18
    v_fma_f32 v145, v145, s45, -v18
    v_fma_f32 v146, v146, s45, -v18
    v_fma_f32 v147, v147, s45, -v18
    v_exp_f32 v132, v132
    v_exp_f32 v133, v133
    v_exp_f32 v134, v134
    v_exp_f32 v135, v135
    v_exp_f32 v136, v136
    v_exp_f32 v137, v137
    v_exp_f32 v138, v138
    v_exp_f32 v139, v139
    v_exp_f32 v140, v140
    v_exp_f32 v141, v141
    v_exp_f32 v142, v142
    v_exp_f32 v143, v143
    v_exp_f32 v144, v144
    v_exp_f32 v145, v145
    v_exp_f32 v146, v146
    v_exp_f32 v147, v147
    v_add_f32 v19, v19, v132
    v_add_f32 v19, v19, v133
    v_add_f32 v19, v19, v134
    v_add_f32 v19, v19, v135
    v_add_f32 v19, v19, v136
    v_add_f32 v19, v19, v137
    v_add_f32 v19, v19, v138
    v_add_f32 v19, v19, v139
    v_add_f32 v19, v19, v140
    v_add_f32 v19, v19, v141
    v_add_f32 v19, v19, v142
    v_add_f32 v19, v19, v143
    v_add_f32 v19, v19, v144
    v_add_f32 v19, v19, v145
    v_add_f32 v19, v19, v146
    v_add_f32 v19, v19, v147
    v_cvt_pk_bf16_f32 v132, v132, v133
    v_cvt_pk_bf16_f32 v133, v134, v135
    v_cvt_pk_bf16_f32 v134, v136, v137
    v_cvt_pk_bf16_f32 v135, v138, v139
    v_cvt_pk_bf16_f32 v136, v140, v141
    v_cvt_pk_bf16_f32 v137, v142, v143
    v_cvt_pk_bf16_f32 v138, v144, v145
    v_cvt_pk_bf16_f32 v139, v146, v147
    ds_write_b128 v6, v[116:119] offset:0
    ds_write_b128 v6, v[120:123] offset:1024
    s_waitcnt lgkmcnt(0)
    s_barrier
    ds_read_b64_tr_b16 v[212:213], v14 offset:8192
    ds_read_b64_tr_b16 v[214:215], v14 offset:10240
    ds_read_b64_tr_b16 v[216:217], v14 offset:12288
    ds_read_b64_tr_b16 v[218:219], v14 offset:14336
    ds_read_b64_tr_b16 v[220:221], v15 offset:8192
    ds_read_b64_tr_b16 v[222:223], v15 offset:10240
    ds_read_b64_tr_b16 v[224:225], v15 offset:12288
    ds_read_b64_tr_b16 v[226:227], v15 offset:14336
    ds_read_b64_tr_b16 v[228:229], v16 offset:8192
    ds_read_b64_tr_b16 v[230:231], v16 offset:10240
    ds_read_b64_tr_b16 v[232:233], v16 offset:12288
    ds_read_b64_tr_b16 v[234:235], v16 offset:14336
    ds_read_b64_tr_b16 v[236:237], v17 offset:8192
    ds_read_b64_tr_b16 v[238:239], v17 offset:10240
    ds_read_b64_tr_b16 v[240:241], v17 offset:12288
    ds_read_b64_tr_b16 v[242:243], v17 offset:14336
    s_waitcnt lgkmcnt(14)
    v_mfma_f32_32x32x16_bf16 v[20:35], v[212:215], v[100:103], v[20:35]
    s_waitcnt lgkmcnt(12)
    v_mfma_f32_32x32x16_bf16 v[20:35], v[216:219], v[104:107], v[20:35]
    s_waitcnt lgkmcnt(10)
    v_mfma_f32_32x32x16_bf16 v[20:35], v[220:223], v[60:63], v[20:35]
    s_waitcnt lgkmcnt(8)
    v_mfma_f32_32x32x16_bf16 v[20:35], v[224:227], v[64:67], v[20:35]
    s_waitcnt lgkmcnt(6)
    v_mfma_f32_32x32x16_bf16 v[20:35], v[228:231], v[68:71], v[20:35]
    s_waitcnt lgkmcnt(4)
    v_mfma_f32_32x32x16_bf16 v[20:35], v[232:235], v[72:75], v[20:35]
    s_waitcnt lgkmcnt(2)
    v_mfma_f32_32x32x16_bf16 v[20:35], v[236:239], v[76:79], v[20:35]
    s_waitcnt lgkmcnt(0)
    v_mfma_f32_32x32x16_bf16 v[20:35], v[240:243], v[80:83], v[20:35]
    ds_read_b128 v[36:39], v7 offset:0
    ds_read_b128 v[40:43], v7 offset:1024
    ds_read_b128 v[44:47], v8 offset:0
    ds_read_b128 v[48:51], v8 offset:1024
    ds_read_b128 v[52:55], v9 offset:0
    ds_read_b128 v[56:59], v9 offset:1024
    v_fma_f32 v148, v148, s45, -v18
    v_fma_f32 v149, v149, s45, -v18
    v_fma_f32 v150, v150, s45, -v18
    v_fma_f32 v151, v151, s45, -v18
    v_fma_f32 v152, v152, s45, -v18
    v_fma_f32 v153, v153, s45, -v18
    v_fma_f32 v154, v154, s45, -v18
    v_fma_f32 v155, v155, s45, -v18
    v_fma_f32 v156, v156, s45, -v18
    v_fma_f32 v157, v157, s45, -v18
    v_fma_f32 v158, v158, s45, -v18
    v_fma_f32 v159, v159, s45, -v18
    v_fma_f32 v160, v160, s45, -v18
    v_fma_f32 v161, v161, s45, -v18
    v_fma_f32 v162, v162, s45, -v18
    v_fma_f32 v163, v163, s45, -v18
    v_exp_f32 v148, v148
    v_exp_f32 v149, v149
    v_exp_f32 v150, v150
    v_exp_f32 v151, v151
    v_exp_f32 v152, v152
    v_exp_f32 v153, v153
    v_exp_f32 v154, v154
    v_exp_f32 v155, v155
    v_exp_f32 v156, v156
    v_exp_f32 v157, v157
    v_exp_f32 v158, v158
    v_exp_f32 v159, v159
    v_exp_f32 v160, v160
    v_exp_f32 v161, v161
    v_exp_f32 v162, v162
    v_exp_f32 v163, v163
    v_add_f32 v19, v19, v148
    v_add_f32 v19, v19, v149
    v_add_f32 v19, v19, v150
    v_add_f32 v19, v19, v151
    v_add_f32 v19, v19, v152
    v_add_f32 v19, v19, v153
    v_add_f32 v19, v19, v154
    v_add_f32 v19, v19, v155
    v_add_f32 v19, v19, v156
    v_add_f32 v19, v19, v157
    v_add_f32 v19, v19, v158
    v_add_f32 v19, v19, v159
    v_add_f32 v19, v19, v160
    v_add_f32 v19, v19, v161
    v_add_f32 v19, v19, v162
    v_add_f32 v19, v19, v163
    v_cvt_pk_bf16_f32 v148, v148, v149
    v_cvt_pk_bf16_f32 v149, v150, v151
    v_cvt_pk_bf16_f32 v150, v152, v153
    v_cvt_pk_bf16_f32 v151, v154, v155
    v_cvt_pk_bf16_f32 v152, v156, v157
    v_cvt_pk_bf16_f32 v153, v158, v159
    v_cvt_pk_bf16_f32 v154, v160, v161
    v_cvt_pk_bf16_f32 v155, v162, v163
    v_fma_f32 v164, v164, s45, -v18
    v_fma_f32 v165, v165, s45, -v18
    v_fma_f32 v166, v166, s45, -v18
    v_fma_f32 v167, v167, s45, -v18
    v_fma_f32 v168, v168, s45, -v18
    v_fma_f32 v169, v169, s45, -v18
    v_fma_f32 v170, v170, s45, -v18
    v_fma_f32 v171, v171, s45, -v18
    v_fma_f32 v172, v172, s45, -v18
    v_fma_f32 v173, v173, s45, -v18
    v_fma_f32 v174, v174, s45, -v18
    v_fma_f32 v175, v175, s45, -v18
    v_fma_f32 v176, v176, s45, -v18
    v_fma_f32 v177, v177, s45, -v18
    v_fma_f32 v178, v178, s45, -v18
    v_fma_f32 v179, v179, s45, -v18
    v_exp_f32 v164, v164
    v_exp_f32 v165, v165
    v_exp_f32 v166, v166
    v_exp_f32 v167, v167
    v_exp_f32 v168, v168
    v_exp_f32 v169, v169
    v_exp_f32 v170, v170
    v_exp_f32 v171, v171
    v_exp_f32 v172, v172
    v_exp_f32 v173, v173
    v_exp_f32 v174, v174
    v_exp_f32 v175, v175
    v_exp_f32 v176, v176
    v_exp_f32 v177, v177
    v_exp_f32 v178, v178
    v_exp_f32 v179, v179
    v_add_f32 v19, v19, v164
    v_add_f32 v19, v19, v165
    v_add_f32 v19, v19, v166
    v_add_f32 v19, v19, v167
    v_add_f32 v19, v19, v168
    v_add_f32 v19, v19, v169
    v_add_f32 v19, v19, v170
    v_add_f32 v19, v19, v171
    v_add_f32 v19, v19, v172
    v_add_f32 v19, v19, v173
    v_add_f32 v19, v19, v174
    v_add_f32 v19, v19, v175
    v_add_f32 v19, v19, v176
    v_add_f32 v19, v19, v177
    v_add_f32 v19, v19, v178
    v_add_f32 v19, v19, v179
    v_cvt_pk_bf16_f32 v164, v164, v165
    v_cvt_pk_bf16_f32 v165, v166, v167
    v_cvt_pk_bf16_f32 v166, v168, v169
    v_cvt_pk_bf16_f32 v167, v170, v171
    v_cvt_pk_bf16_f32 v168, v172, v173
    v_cvt_pk_bf16_f32 v169, v174, v175
    v_cvt_pk_bf16_f32 v170, v176, v177
    v_cvt_pk_bf16_f32 v171, v178, v179
    ds_write_b128 v6, v[132:135] offset:8192
    ds_write_b128 v6, v[136:139] offset:9216
    s_waitcnt lgkmcnt(0)
    s_barrier
    ds_read_b64_tr_b16 v[212:213], v14 offset:16384
    ds_read_b64_tr_b16 v[214:215], v14 offset:18432
    ds_read_b64_tr_b16 v[216:217], v14 offset:20480
    ds_read_b64_tr_b16 v[218:219], v14 offset:22528
    ds_read_b64_tr_b16 v[220:221], v15 offset:16384
    ds_read_b64_tr_b16 v[222:223], v15 offset:18432
    ds_read_b64_tr_b16 v[224:225], v15 offset:20480
    ds_read_b64_tr_b16 v[226:227], v15 offset:22528
    ds_read_b64_tr_b16 v[228:229], v16 offset:16384
    ds_read_b64_tr_b16 v[230:231], v16 offset:18432
    ds_read_b64_tr_b16 v[232:233], v16 offset:20480
    ds_read_b64_tr_b16 v[234:235], v16 offset:22528
    ds_read_b64_tr_b16 v[236:237], v17 offset:16384
    ds_read_b64_tr_b16 v[238:239], v17 offset:18432
    ds_read_b64_tr_b16 v[240:241], v17 offset:20480
    ds_read_b64_tr_b16 v[242:243], v17 offset:22528
    s_waitcnt lgkmcnt(14)
    v_mfma_f32_32x32x16_bf16 v[20:35], v[212:215], v[116:119], v[20:35]
    s_waitcnt lgkmcnt(12)
    v_mfma_f32_32x32x16_bf16 v[20:35], v[216:219], v[120:123], v[20:35]
    s_waitcnt lgkmcnt(10)
    v_mfma_f32_32x32x16_bf16 v[20:35], v[220:223], v[36:39], v[20:35]
    s_waitcnt lgkmcnt(8)
    v_mfma_f32_32x32x16_bf16 v[20:35], v[224:227], v[40:43], v[20:35]
    s_waitcnt lgkmcnt(6)
    v_mfma_f32_32x32x16_bf16 v[20:35], v[228:231], v[44:47], v[20:35]
    s_waitcnt lgkmcnt(4)
    v_mfma_f32_32x32x16_bf16 v[20:35], v[232:235], v[48:51], v[20:35]
    s_waitcnt lgkmcnt(2)
    v_mfma_f32_32x32x16_bf16 v[20:35], v[236:239], v[52:55], v[20:35]
    s_waitcnt lgkmcnt(0)
    v_mfma_f32_32x32x16_bf16 v[20:35], v[240:243], v[56:59], v[20:35]
    ds_read_b128 v[60:63], v7 offset:8192
    ds_read_b128 v[64:67], v7 offset:9216
    ds_read_b128 v[68:71], v8 offset:8192
    ds_read_b128 v[72:75], v8 offset:9216
    ds_read_b128 v[76:79], v9 offset:8192
    ds_read_b128 v[80:83], v9 offset:9216
    v_cvt_pk_bf16_f32 v180, v180, v181
    v_cvt_pk_bf16_f32 v182, v182, v183
    v_cvt_pk_bf16_f32 v184, v184, v185
    v_cvt_pk_bf16_f32 v186, v186, v187
    v_cvt_pk_bf16_f32 v188, v188, v189
    v_cvt_pk_bf16_f32 v190, v190, v191
    v_cvt_pk_bf16_f32 v192, v192, v193
    v_cvt_pk_bf16_f32 v194, v194, v195
    v_and_b32 v181, 0xffff0000, v180
    v_lshlrev_b32 v180, 16, v180
    v_and_b32 v183, 0xffff0000, v182
    v_lshlrev_b32 v182, 16, v182
    v_and_b32 v185, 0xffff0000, v184
    v_lshlrev_b32 v184, 16, v184
    v_and_b32 v187, 0xffff0000, v186
    v_lshlrev_b32 v186, 16, v186
    v_and_b32 v189, 0xffff0000, v188
    v_lshlrev_b32 v188, 16, v188
    v_and_b32 v191, 0xffff0000, v190
    v_lshlrev_b32 v190, 16, v190
    v_and_b32 v193, 0xffff0000, v192
    v_lshlrev_b32 v192, 16, v192
    v_and_b32 v195, 0xffff0000, v194
    v_lshlrev_b32 v194, 16, v194
    v_pk_mul_f32 v[180:181], v[180:181], s[58:59]
    v_pk_mul_f32 v[182:183], v[182:183], s[58:59]
    v_pk_mul_f32 v[184:185], v[184:185], s[58:59]
    v_pk_mul_f32 v[186:187], v[186:187], s[58:59]
    v_pk_mul_f32 v[188:189], v[188:189], s[58:59]
    v_pk_mul_f32 v[190:191], v[190:191], s[58:59]
    v_pk_mul_f32 v[192:193], v[192:193], s[58:59]
    v_pk_mul_f32 v[194:195], v[194:195], s[58:59]
    v_cvt_pk_bf16_f32 v180, v180, v181
    v_cvt_pk_bf16_f32 v182, v182, v183
    v_cvt_pk_bf16_f32 v184, v184, v185
    v_cvt_pk_bf16_f32 v186, v186, v187
    v_cvt_pk_bf16_f32 v188, v188, v189
    v_cvt_pk_bf16_f32 v190, v190, v191
    v_cvt_pk_bf16_f32 v192, v192, v193
    v_cvt_pk_bf16_f32 v194, v194, v195
    v_and_b32 v181, 0xffff0000, v180
    v_lshlrev_b32 v180, 16, v180
    v_and_b32 v183, 0xffff0000, v182
    v_lshlrev_b32 v182, 16, v182
    v_and_b32 v185, 0xffff0000, v184
    v_lshlrev_b32 v184, 16, v184
    v_and_b32 v187, 0xffff0000, v186
    v_lshlrev_b32 v186, 16, v186
    v_and_b32 v189, 0xffff0000, v188
    v_lshlrev_b32 v188, 16, v188
    v_and_b32 v191, 0xffff0000, v190
    v_lshlrev_b32 v190, 16, v190
    v_and_b32 v193, 0xffff0000, v192
    v_lshlrev_b32 v192, 16, v192
    v_and_b32 v195, 0xffff0000, v194
    v_lshlrev_b32 v194, 16, v194
    v_fma_f32 v180, v180, s45, -v18
    v_fma_f32 v181, v181, s45, -v18
    v_fma_f32 v182, v182, s45, -v18
    v_fma_f32 v183, v183, s45, -v18
    v_fma_f32 v184, v184, s45, -v18
    v_fma_f32 v185, v185, s45, -v18
    v_fma_f32 v186, v186, s45, -v18
    v_fma_f32 v187, v187, s45, -v18
    v_fma_f32 v188, v188, s45, -v18
    v_fma_f32 v189, v189, s45, -v18
    v_fma_f32 v190, v190, s45, -v18
    v_fma_f32 v191, v191, s45, -v18
    v_fma_f32 v192, v192, s45, -v18
    v_fma_f32 v193, v193, s45, -v18
    v_fma_f32 v194, v194, s45, -v18
    v_fma_f32 v195, v195, s45, -v18
    v_exp_f32 v180, v180
    v_exp_f32 v181, v181
    v_exp_f32 v182, v182
    v_exp_f32 v183, v183
    v_exp_f32 v184, v184
    v_exp_f32 v185, v185
    v_exp_f32 v186, v186
    v_exp_f32 v187, v187
    v_exp_f32 v188, v188
    v_exp_f32 v189, v189
    v_exp_f32 v190, v190
    v_exp_f32 v191, v191
    v_exp_f32 v192, v192
    v_exp_f32 v193, v193
    v_exp_f32 v194, v194
    v_exp_f32 v195, v195
    v_add_f32 v19, v19, v180
    v_add_f32 v19, v19, v181
    v_add_f32 v19, v19, v182
    v_add_f32 v19, v19, v183
    v_add_f32 v19, v19, v184
    v_add_f32 v19, v19, v185
    v_add_f32 v19, v19, v186
    v_add_f32 v19, v19, v187
    v_add_f32 v19, v19, v188
    v_add_f32 v19, v19, v189
    v_add_f32 v19, v19, v190
    v_add_f32 v19, v19, v191
    v_add_f32 v19, v19, v192
    v_add_f32 v19, v19, v193
    v_add_f32 v19, v19, v194
    v_add_f32 v19, v19, v195
    v_cvt_pk_bf16_f32 v180, v180, v181
    v_cvt_pk_bf16_f32 v181, v182, v183
    v_cvt_pk_bf16_f32 v182, v184, v185
    v_cvt_pk_bf16_f32 v183, v186, v187
    v_cvt_pk_bf16_f32 v184, v188, v189
    v_cvt_pk_bf16_f32 v185, v190, v191
    v_cvt_pk_bf16_f32 v186, v192, v193
    v_cvt_pk_bf16_f32 v187, v194, v195
    v_cvt_pk_bf16_f32 v196, v196, v197
    v_cvt_pk_bf16_f32 v198, v198, v199
    v_cvt_pk_bf16_f32 v200, v200, v201
    v_cvt_pk_bf16_f32 v202, v202, v203
    v_cvt_pk_bf16_f32 v204, v204, v205
    v_cvt_pk_bf16_f32 v206, v206, v207
    v_cvt_pk_bf16_f32 v208, v208, v209
    v_cvt_pk_bf16_f32 v210, v210, v211
    v_and_b32 v197, 0xffff0000, v196
    v_lshlrev_b32 v196, 16, v196
    v_and_b32 v199, 0xffff0000, v198
    v_lshlrev_b32 v198, 16, v198
    v_and_b32 v201, 0xffff0000, v200
    v_lshlrev_b32 v200, 16, v200
    v_and_b32 v203, 0xffff0000, v202
    v_lshlrev_b32 v202, 16, v202
    v_and_b32 v205, 0xffff0000, v204
    v_lshlrev_b32 v204, 16, v204
    v_and_b32 v207, 0xffff0000, v206
    v_lshlrev_b32 v206, 16, v206
    v_and_b32 v209, 0xffff0000, v208
    v_lshlrev_b32 v208, 16, v208
    v_and_b32 v211, 0xffff0000, v210
    v_lshlrev_b32 v210, 16, v210
    v_pk_mul_f32 v[196:197], v[196:197], s[58:59]
    v_pk_mul_f32 v[198:199], v[198:199], s[58:59]
    v_pk_mul_f32 v[200:201], v[200:201], s[58:59]
    v_pk_mul_f32 v[202:203], v[202:203], s[58:59]
    v_pk_mul_f32 v[204:205], v[204:205], s[58:59]
    v_pk_mul_f32 v[206:207], v[206:207], s[58:59]
    v_pk_mul_f32 v[208:209], v[208:209], s[58:59]
    v_pk_mul_f32 v[210:211], v[210:211], s[58:59]
    v_cvt_pk_bf16_f32 v196, v196, v197
    v_cvt_pk_bf16_f32 v198, v198, v199
    v_cvt_pk_bf16_f32 v200, v200, v201
    v_cvt_pk_bf16_f32 v202, v202, v203
    v_cvt_pk_bf16_f32 v204, v204, v205
    v_cvt_pk_bf16_f32 v206, v206, v207
    v_cvt_pk_bf16_f32 v208, v208, v209
    v_cvt_pk_bf16_f32 v210, v210, v211
    v_and_b32 v197, 0xffff0000, v196
    v_lshlrev_b32 v196, 16, v196
    v_and_b32 v199, 0xffff0000, v198
    v_lshlrev_b32 v198, 16, v198
    v_and_b32 v201, 0xffff0000, v200
    v_lshlrev_b32 v200, 16, v200
    v_and_b32 v203, 0xffff0000, v202
    v_lshlrev_b32 v202, 16, v202
    v_and_b32 v205, 0xffff0000, v204
    v_lshlrev_b32 v204, 16, v204
    v_and_b32 v207, 0xffff0000, v206
    v_lshlrev_b32 v206, 16, v206
    v_and_b32 v209, 0xffff0000, v208
    v_lshlrev_b32 v208, 16, v208
    v_and_b32 v211, 0xffff0000, v210
    v_lshlrev_b32 v210, 16, v210
    v_fma_f32 v196, v196, s45, -v18
    v_fma_f32 v197, v197, s45, -v18
    v_fma_f32 v198, v198, s45, -v18
    v_fma_f32 v199, v199, s45, -v18
    v_fma_f32 v200, v200, s45, -v18
    v_fma_f32 v201, v201, s45, -v18
    v_fma_f32 v202, v202, s45, -v18
    v_fma_f32 v203, v203, s45, -v18
    v_fma_f32 v204, v204, s45, -v18
    v_fma_f32 v205, v205, s45, -v18
    v_fma_f32 v206, v206, s45, -v18
    v_fma_f32 v207, v207, s45, -v18
    v_fma_f32 v208, v208, s45, -v18
    v_fma_f32 v209, v209, s45, -v18
    v_fma_f32 v210, v210, s45, -v18
    v_fma_f32 v211, v211, s45, -v18
    v_exp_f32 v196, v196
    v_exp_f32 v197, v197
    v_exp_f32 v198, v198
    v_exp_f32 v199, v199
    v_exp_f32 v200, v200
    v_exp_f32 v201, v201
    v_exp_f32 v202, v202
    v_exp_f32 v203, v203
    v_exp_f32 v204, v204
    v_exp_f32 v205, v205
    v_exp_f32 v206, v206
    v_exp_f32 v207, v207
    v_exp_f32 v208, v208
    v_exp_f32 v209, v209
    v_exp_f32 v210, v210
    v_exp_f32 v211, v211
    v_add_f32 v19, v19, v196
    v_add_f32 v19, v19, v197
    v_add_f32 v19, v19, v198
    v_add_f32 v19, v19, v199
    v_add_f32 v19, v19, v200
    v_add_f32 v19, v19, v201
    v_add_f32 v19, v19, v202
    v_add_f32 v19, v19, v203
    v_add_f32 v19, v19, v204
    v_add_f32 v19, v19, v205
    v_add_f32 v19, v19, v206
    v_add_f32 v19, v19, v207
    v_add_f32 v19, v19, v208
    v_add_f32 v19, v19, v209
    v_add_f32 v19, v19, v210
    v_add_f32 v19, v19, v211
    v_cvt_pk_bf16_f32 v196, v196, v197
    v_cvt_pk_bf16_f32 v197, v198, v199
    v_cvt_pk_bf16_f32 v198, v200, v201
    v_cvt_pk_bf16_f32 v199, v202, v203
    v_cvt_pk_bf16_f32 v200, v204, v205
    v_cvt_pk_bf16_f32 v201, v206, v207
    v_cvt_pk_bf16_f32 v202, v208, v209
    v_cvt_pk_bf16_f32 v203, v210, v211
    ds_write_b128 v6, v[148:151] offset:0
    ds_write_b128 v6, v[152:155] offset:1024
    v_mov_b32 v244, v19
    s_nop 1
    v_permlane32_swap_b32 v244, v19
    v_add_f32 v19, v244, v19
    ds_write_b32 v10, v19 offset:17408
    s_waitcnt lgkmcnt(0)
    s_barrier
    ds_read_b64_tr_b16 v[212:213], v14 offset:24576
    ds_read_b64_tr_b16 v[214:215], v14 offset:26624
    ds_read_b64_tr_b16 v[216:217], v14 offset:28672
    ds_read_b64_tr_b16 v[218:219], v14 offset:30720
    ds_read_b64_tr_b16 v[220:221], v15 offset:24576
    ds_read_b64_tr_b16 v[222:223], v15 offset:26624
    ds_read_b64_tr_b16 v[224:225], v15 offset:28672
    ds_read_b64_tr_b16 v[226:227], v15 offset:30720
    ds_read_b64_tr_b16 v[228:229], v16 offset:24576
    ds_read_b64_tr_b16 v[230:231], v16 offset:26624
    ds_read_b64_tr_b16 v[232:233], v16 offset:28672
    ds_read_b64_tr_b16 v[234:235], v16 offset:30720
    ds_read_b64_tr_b16 v[236:237], v17 offset:24576
    ds_read_b64_tr_b16 v[238:239], v17 offset:26624
    ds_read_b64_tr_b16 v[240:241], v17 offset:28672
    ds_read_b64_tr_b16 v[242:243], v17 offset:30720
    s_waitcnt lgkmcnt(14)
    v_mfma_f32_32x32x16_bf16 v[20:35], v[212:215], v[132:135], v[20:35]
    s_waitcnt lgkmcnt(12)
    v_mfma_f32_32x32x16_bf16 v[20:35], v[216:219], v[136:139], v[20:35]
    s_waitcnt lgkmcnt(10)
    v_mfma_f32_32x32x16_bf16 v[20:35], v[220:223], v[60:63], v[20:35]
    s_waitcnt lgkmcnt(8)
    v_mfma_f32_32x32x16_bf16 v[20:35], v[224:227], v[64:67], v[20:35]
    s_waitcnt lgkmcnt(6)
    v_mfma_f32_32x32x16_bf16 v[20:35], v[228:231], v[68:71], v[20:35]
    s_waitcnt lgkmcnt(4)
    v_mfma_f32_32x32x16_bf16 v[20:35], v[232:235], v[72:75], v[20:35]
    s_waitcnt lgkmcnt(2)
    v_mfma_f32_32x32x16_bf16 v[20:35], v[236:239], v[76:79], v[20:35]
    s_waitcnt lgkmcnt(0)
    v_mfma_f32_32x32x16_bf16 v[20:35], v[240:243], v[80:83], v[20:35]
    ds_read_b128 v[36:39], v7 offset:0
    ds_read_b128 v[40:43], v7 offset:1024
    ds_read_b128 v[44:47], v8 offset:0
    ds_read_b128 v[48:51], v8 offset:1024
    ds_read_b128 v[52:55], v9 offset:0
    ds_read_b128 v[56:59], v9 offset:1024
    ds_write_b128 v6, v[164:167] offset:8192
    ds_write_b128 v6, v[168:171] offset:9216
    s_waitcnt lgkmcnt(0)
    s_barrier
    ds_read_b64_tr_b16 v[212:213], v14 offset:0
    ds_read_b64_tr_b16 v[214:215], v14 offset:2048
    ds_read_b64_tr_b16 v[216:217], v14 offset:4096
    ds_read_b64_tr_b16 v[218:219], v14 offset:6144
    ds_read_b64_tr_b16 v[220:221], v15 offset:0
    ds_read_b64_tr_b16 v[222:223], v15 offset:2048
    ds_read_b64_tr_b16 v[224:225], v15 offset:4096
    ds_read_b64_tr_b16 v[226:227], v15 offset:6144
    ds_read_b64_tr_b16 v[228:229], v16 offset:0
    ds_read_b64_tr_b16 v[230:231], v16 offset:2048
    ds_read_b64_tr_b16 v[232:233], v16 offset:4096
    ds_read_b64_tr_b16 v[234:235], v16 offset:6144
    ds_read_b64_tr_b16 v[236:237], v17 offset:0
    ds_read_b64_tr_b16 v[238:239], v17 offset:2048
    ds_read_b64_tr_b16 v[240:241], v17 offset:4096
    ds_read_b64_tr_b16 v[242:243], v17 offset:6144
    s_waitcnt lgkmcnt(14)
    v_mfma_f32_32x32x16_bf16 v[20:35], v[212:215], v[148:151], v[20:35]
    s_waitcnt lgkmcnt(12)
    v_mfma_f32_32x32x16_bf16 v[20:35], v[216:219], v[152:155], v[20:35]
    s_waitcnt lgkmcnt(10)
    v_mfma_f32_32x32x16_bf16 v[20:35], v[220:223], v[36:39], v[20:35]
    s_waitcnt lgkmcnt(8)
    v_mfma_f32_32x32x16_bf16 v[20:35], v[224:227], v[40:43], v[20:35]
    s_waitcnt lgkmcnt(6)
    v_mfma_f32_32x32x16_bf16 v[20:35], v[228:231], v[44:47], v[20:35]
    s_waitcnt lgkmcnt(4)
    v_mfma_f32_32x32x16_bf16 v[20:35], v[232:235], v[48:51], v[20:35]
    s_waitcnt lgkmcnt(2)
    v_mfma_f32_32x32x16_bf16 v[20:35], v[236:239], v[52:55], v[20:35]
    s_waitcnt lgkmcnt(0)
    v_mfma_f32_32x32x16_bf16 v[20:35], v[240:243], v[56:59], v[20:35]
    ds_read_b128 v[60:63], v7 offset:8192
    ds_read_b128 v[64:67], v7 offset:9216
    ds_read_b128 v[68:71], v8 offset:8192
    ds_read_b128 v[72:75], v8 offset:9216
    ds_read_b128 v[76:79], v9 offset:8192
    ds_read_b128 v[80:83], v9 offset:9216
    ds_write_b128 v6, v[180:183] offset:0
    ds_write_b128 v6, v[184:187] offset:1024
    s_waitcnt lgkmcnt(0)
    s_barrier
    ds_read_b64_tr_b16 v[212:213], v14 offset:8192
    ds_read_b64_tr_b16 v[214:215], v14 offset:10240
    ds_read_b64_tr_b16 v[216:217], v14 offset:12288
    ds_read_b64_tr_b16 v[218:219], v14 offset:14336
    ds_read_b64_tr_b16 v[220:221], v15 offset:8192
    ds_read_b64_tr_b16 v[222:223], v15 offset:10240
    ds_read_b64_tr_b16 v[224:225], v15 offset:12288
    ds_read_b64_tr_b16 v[226:227], v15 offset:14336
    ds_read_b64_tr_b16 v[228:229], v16 offset:8192
    ds_read_b64_tr_b16 v[230:231], v16 offset:10240
    ds_read_b64_tr_b16 v[232:233], v16 offset:12288
    ds_read_b64_tr_b16 v[234:235], v16 offset:14336
    ds_read_b64_tr_b16 v[236:237], v17 offset:8192
    ds_read_b64_tr_b16 v[238:239], v17 offset:10240
    ds_read_b64_tr_b16 v[240:241], v17 offset:12288
    ds_read_b64_tr_b16 v[242:243], v17 offset:14336
    s_waitcnt lgkmcnt(14)
    v_mfma_f32_32x32x16_bf16 v[20:35], v[212:215], v[164:167], v[20:35]
    s_waitcnt lgkmcnt(12)
    v_mfma_f32_32x32x16_bf16 v[20:35], v[216:219], v[168:171], v[20:35]
    s_waitcnt lgkmcnt(10)
    v_mfma_f32_32x32x16_bf16 v[20:35], v[220:223], v[60:63], v[20:35]
    s_waitcnt lgkmcnt(8)
    v_mfma_f32_32x32x16_bf16 v[20:35], v[224:227], v[64:67], v[20:35]
    s_waitcnt lgkmcnt(6)
    v_mfma_f32_32x32x16_bf16 v[20:35], v[228:231], v[68:71], v[20:35]
    s_waitcnt lgkmcnt(4)
    v_mfma_f32_32x32x16_bf16 v[20:35], v[232:235], v[72:75], v[20:35]
    s_waitcnt lgkmcnt(2)
    v_mfma_f32_32x32x16_bf16 v[20:35], v[236:239], v[76:79], v[20:35]
    s_waitcnt lgkmcnt(0)
    v_mfma_f32_32x32x16_bf16 v[20:35], v[240:243], v[80:83], v[20:35]
    ds_read_b128 v[36:39], v7 offset:0
    ds_read_b128 v[40:43], v7 offset:1024
    ds_read_b128 v[44:47], v8 offset:0
    ds_read_b128 v[48:51], v8 offset:1024
    ds_read_b128 v[52:55], v9 offset:0
    ds_read_b128 v[56:59], v9 offset:1024
    s_cmp_lg_u32 s36, 0
    s_cbranch_scc1 L_noml
    ds_read_b32 v244, v11 offset:17408
    ds_read_b32 v245, v12 offset:17408
    ds_read_b32 v246, v13 offset:17408
    s_waitcnt lgkmcnt(0)
    v_add_f32 v244, v244, v245
    v_add_f32 v19, v19, v246
    v_add_f32 v19, v19, v244
    s_mov_b32 exec_hi, 0
    buffer_store_dwordx2 v[18:19], v2, s[28:31], s49 offen sc1
    s_mov_b32 exec_hi, -1
L_noml:
    ds_write_b128 v6, v[196:199] offset:8192
    ds_write_b128 v6, v[200:203] offset:9216
    s_waitcnt lgkmcnt(0)
    s_barrier
    ds_read_b64_tr_b16 v[212:213], v14 offset:16384
    ds_read_b64_tr_b16 v[214:215], v14 offset:18432
    ds_read_b64_tr_b16 v[216:217], v14 offset:20480
    ds_read_b64_tr_b16 v[218:219], v14 offset:22528
    ds_read_b64_tr_b16 v[220:221], v15 offset:16384
    ds_read_b64_tr_b16 v[222:223], v15 offset:18432
    ds_read_b64_tr_b16 v[224:225], v15 offset:20480
    ds_read_b64_tr_b16 v[226:227], v15 offset:22528
    ds_read_b64_tr_b16 v[228:229], v16 offset:16384
    ds_read_b64_tr_b16 v[230:231], v16 offset:18432
    ds_read_b64_tr_b16 v[232:233], v16 offset:20480
    ds_read_b64_tr_b16 v[234:235], v16 offset:22528
    ds_read_b64_tr_b16 v[236:237], v17 offset:16384
    ds_read_b64_tr_b16 v[238:239], v17 offset:18432
    ds_read_b64_tr_b16 v[240:241], v17 offset:20480
    ds_read_b64_tr_b16 v[242:243], v17 offset:22528
    s_waitcnt lgkmcnt(14)
    v_mfma_f32_32x32x16_bf16 v[20:35], v[212:215], v[180:183], v[20:35]
    s_waitcnt lgkmcnt(12)
    v_mfma_f32_32x32x16_bf16 v[20:35], v[216:219], v[184:187], v[20:35]
    s_waitcnt lgkmcnt(10)
    v_mfma_f32_32x32x16_bf16 v[20:35], v[220:223], v[36:39], v[20:35]
    s_waitcnt lgkmcnt(8)
    v_mfma_f32_32x32x16_bf16 v[20:35], v[224:227], v[40:43], v[20:35]
    s_waitcnt lgkmcnt(6)
    v_mfma_f32_32x32x16_bf16 v[20:35], v[228:231], v[44:47], v[20:35]
    s_waitcnt lgkmcnt(4)
    v_mfma_f32_32x32x16_bf16 v[20:35], v[232:235], v[48:51], v[20:35]
    s_waitcnt lgkmcnt(2)
    v_mfma_f32_32x32x16_bf16 v[20:35], v[236:239], v[52:55], v[20:35]
    s_waitcnt lgkmcnt(0)
    v_mfma_f32_32x32x16_bf16 v[20:35], v[240:243], v[56:59], v[20:35]
    ds_read_b128 v[60:63], v7 offset:8192
    ds_read_b128 v[64:67], v7 offset:9216
    ds_read_b128 v[68:71], v8 offset:8192
    ds_read_b128 v[72:75], v8 offset:9216
    ds_read_b128 v[76:79], v9 offset:8192
    ds_read_b128 v[80:83], v9 offset:9216
    s_waitcnt vmcnt(0) lgkmcnt(0)
    s_barrier
    ds_read_b64_tr_b16 v[212:213], v14 offset:24576
    ds_read_b64_tr_b16 v[214:215], v14 offset:26624
    ds_read_b64_tr_b16 v[216:217], v15 offset:24576
    ds_read_b64_tr_b16 v[218:219], v15 offset:26624
    ds_read_b64_tr_b16 v[220:221], v16 offset:24576
    ds_read_b64_tr_b16 v[222:223], v16 offset:26624
    ds_read_b64_tr_b16 v[224:225], v17 offset:24576
    ds_read_b64_tr_b16 v[226:227], v17 offset:26624
    s_mov_b64 exec, 1
    buffer_atomic_and v252, v252, s[28:31], s50 offen
    s_mov_b64 exec, -1
    s_waitcnt lgkmcnt(6)
    v_mfma_f32_32x32x16_bf16 v[20:35], v[212:215], v[196:199], v[20:35]
    s_waitcnt lgkmcnt(4)
    v_mfma_f32_32x32x16_bf16 v[20:35], v[216:219], v[60:63], v[20:35]
    s_waitcnt lgkmcnt(2)
    v_mfma_f32_32x32x16_bf16 v[20:35], v[220:223], v[68:71], v[20:35]
    s_waitcnt lgkmcnt(0)
    v_mfma_f32_32x32x16_bf16 v[20:35], v[224:227], v[76:79], v[20:35]
    s_barrier
    ds_read_b64_tr_b16 v[228:229], v14 offset:28672
    ds_read_b64_tr_b16 v[230:231], v14 offset:30720
    ds_read_b64_tr_b16 v[232:233], v15 offset:28672
    ds_read_b64_tr_b16 v[234:235], v15 offset:30720
    ds_read_b64_tr_b16 v[236:237], v16 offset:28672
    ds_read_b64_tr_b16 v[238:239], v16 offset:30720
    ds_read_b64_tr_b16 v[240:241], v17 offset:28672
    ds_read_b64_tr_b16 v[242:243], v17 offset:30720
    s_waitcnt lgkmcnt(6)
    v_mfma_f32_32x32x16_bf16 v[20:35], v[228:231], v[200:203], v[20:35]
    s_waitcnt lgkmcnt(4)
    v_mfma_f32_32x32x16_bf16 v[20:35], v[232:235], v[64:67], v[20:35]
    s_waitcnt lgkmcnt(2)
    v_mfma_f32_32x32x16_bf16 v[20:35], v[236:239], v[72:75], v[20:35]
    s_waitcnt lgkmcnt(0)
    v_mfma_f32_32x32x16_bf16 v[20:35], v[240:243], v[80:83], v[20:35]
    s_nop 11
    v_cvt_pk_bf16_f32 v212, v20, v21
    v_cvt_pk_bf16_f32 v213, v22, v23
    v_cvt_pk_bf16_f32 v214, v24, v25
    v_cvt_pk_bf16_f32 v215, v26, v27
    buffer_store_dwordx4 v[212:215], v1, s[28:31], s47 offen offset:0 sc1
    v_cvt_pk_bf16_f32 v216, v28, v29
    v_cvt_pk_bf16_f32 v217, v30, v31
    v_cvt_pk_bf16_f32 v218, v32, v33
    v_cvt_pk_bf16_f32 v219, v34, v35
    buffer_store_dwordx4 v[216:219], v1, s[28:31], s47 offen offset:128 sc1
    s_mov_b64 exec, 1
    s_waitcnt vmcnt(0)
    buffer_atomic_or v253, v252, s[28:31], s50 offen sc0
    s_sleep 5
    buffer_atomic_or v254, v252, s[28:31], s50 offen sc0
L_poll:
    s_waitcnt vmcnt(1)
    v_or_b32 v253, s55, v253
    v_cmp_eq_u32 vcc, s54, v253
    s_cbranch_vccnz L_poll_ok
    v_mov_b32 v253, s55
    buffer_atomic_or v253, v252, s[28:31], s50 offen sc0
    s_waitcnt vmcnt(1)
    v_or_b32 v254, s55, v254
    v_cmp_eq_u32 vcc, s54, v254
    s_cbranch_vccnz L_poll_ok
    v_mov_b32 v254, s55
    buffer_atomic_or v254, v252, s[28:31], s50 offen sc0
    s_sub_u32 s43, s43, 1
    s_cmp_gt_i32 s43, 0
    s_cbranch_scc1 L_poll
L_poll_ok:
    s_mov_b64 exec, -1
    buffer_load_dwordx2 v[116:117], v4, s[28:31], s48 offen sc1
    buffer_load_dwordx2 v[118:119], v4, s[28:31], s48 offen offset:1024 sc1
    buffer_load_dwordx4 v[84:87], v3, s[28:31], s46 offen sc1
    buffer_load_dwordx4 v[88:91], v3, s[28:31], s46 offen offset:1024 sc1
    s_waitcnt vmcnt(2)
    v_max_f32 v120, v116, v118
    v_max_f32 v121, v116, v118
    s_waitcnt vmcnt(1)
    v_lshlrev_b32 v92, 16, v84
    v_permlane16_swap_b32 v120, v121
    v_and_b32 v93, 0xffff0000, v84
    v_max_f32 v120, v120, v121
    v_lshlrev_b32 v94, 16, v85
    v_mov_b32 v121, v120
    v_and_b32 v95, 0xffff0000, v85
    v_lshlrev_b32 v96, 16, v86
    v_permlane32_swap_b32 v120, v121
    v_and_b32 v97, 0xffff0000, v86
    v_max_f32 v120, v120, v121
    v_sub_f32 v122, v116, v120
    v_sub_f32 v124, v118, v120
    v_exp_f32 v122, v122
    v_exp_f32 v124, v124
    v_lshlrev_b32 v98, 16, v87
    v_and_b32 v99, 0xffff0000, v87
    v_mul_f32 v128, v122, v117
    v_fmac_f32 v128, v124, v119
    s_waitcnt vmcnt(0)
    v_mov_b32 v121, v128
    v_lshlrev_b32 v100, 16, v88
    v_and_b32 v101, 0xffff0000, v88
    v_lshlrev_b32 v102, 16, v89
    v_and_b32 v103, 0xffff0000, v89
    v_lshlrev_b32 v104, 16, v90
    v_and_b32 v105, 0xffff0000, v90
    v_lshlrev_b32 v106, 16, v91
    v_and_b32 v107, 0xffff0000, v91
    v_permlane16_swap_b32 v128, v121
    v_pk_mul_f32 v[92:93], v[92:93], v[122:123] op_sel_hi:[1,0]
    v_pk_mul_f32 v[94:95], v[94:95], v[122:123] op_sel_hi:[1,0]
    v_pk_mul_f32 v[96:97], v[96:97], v[122:123] op_sel_hi:[1,0]
    v_pk_mul_f32 v[98:99], v[98:99], v[122:123] op_sel_hi:[1,0]
    v_add_f32 v128, v128, v121
    v_pk_fma_f32 v[92:93], v[100:101], v[124:125], v[92:93] op_sel_hi:[1,0,1]
    v_pk_fma_f32 v[94:95], v[102:103], v[124:125], v[94:95] op_sel_hi:[1,0,1]
    v_mov_b32 v121, v128
    v_pk_fma_f32 v[96:97], v[104:105], v[124:125], v[96:97] op_sel_hi:[1,0,1]
    v_pk_fma_f32 v[98:99], v[106:107], v[124:125], v[98:99] op_sel_hi:[1,0,1]
    v_permlane32_swap_b32 v128, v121
    v_add_f32 v128, v128, v121
    v_permlane32_swap_b32 v92, v96
    v_permlane32_swap_b32 v93, v97
    v_permlane32_swap_b32 v94, v98
    v_permlane32_swap_b32 v95, v99
    v_rcp_f32 v128, v128
    v_add_f32 v92, v92, v96
    v_add_f32 v94, v94, v98
    v_add_f32 v93, v93, v97
    v_add_f32 v95, v95, v99
    v_permlane16_swap_b32 v92, v94
    s_nop 0
    v_permlane16_swap_b32 v93, v95
    v_add_f32 v92, v92, v94
    v_add_f32 v93, v93, v95
    v_mul_f32 v92, v92, v128
    v_mul_f32 v93, v93, v128
    v_cvt_pk_bf16_f32 v92, v92, v93
    buffer_store_dword v92, v5, s[24:27], s52 offen
L_end:
    s_endpgm
.section .rodata,"a"
.p2align 6
.amdhsa_kernel standalone__gqa_softmax__sampling_kernel
  .amdhsa_next_free_vgpr 256
  .amdhsa_next_free_sgpr 64
  .amdhsa_accum_offset 256
  .amdhsa_group_segment_fixed_size 0
  .amdhsa_kernarg_size 48
  .amdhsa_user_sgpr_count 2
  .amdhsa_user_sgpr_kernarg_segment_ptr 1
  .amdhsa_system_sgpr_workgroup_id_x 1
  .amdhsa_float_denorm_mode_32 3
.end_amdhsa_kernel
```
